```python
import torch

def _softmax(x, axis=-1):
    return torch.softmax(x, dim=axis)
def _gelu(x):
    return torch.nn.functional.gelu(x, approximate="tanh")
def _silu(x):
    return torch.nn.functional.silu(x)
def _sigmoid(x):
    return torch.sigmoid(x)
def _layernorm(x, axis=-1, eps=1e-5):
    m = x.mean(dim=axis, keepdim=True)
    v = x.var(dim=axis, keepdim=True, unbiased=False)
    return (x - m) / torch.sqrt(v + eps)
def _scatter_add(tgt, idx, src, axis=0):
    return tgt.clone().index_add_(axis, idx, src)
def _segment_sum(src, seg, n):
    out = torch.zeros((n,) + src.shape[1:], dtype=src.dtype)
    return out.index_add_(0, seg, src)
def _pad(x, pw):
    flat = tuple(v for pair in reversed(pw) for v in pair)
    return torch.nn.functional.pad(x, flat)

kernel_name = 'standalone__ssm_conv_s4d__prompt'

def setup_inputs():

    _w = (lambda a: (lambda t: t.to(torch.bfloat16) if t.is_floating_point() else t)(torch.as_tensor(a)))
    Bsz, L, D, N = 1, 2048, 448, 256
    return {
        "u": _w((lambda *s: torch.randn(*s, dtype=torch.bfloat16) * 0.05)(Bsz, L, D)),
        "log_A_real": _w((lambda *s: torch.randn(*s, dtype=torch.bfloat16) * 6.4)(D, N) * 0.5),
        "A_imag": _w((lambda *s: torch.randn(*s, dtype=torch.bfloat16) * 0.05)(D, N) * 3.14),
        "C_real": _w((lambda *s: torch.randn(*s, dtype=torch.bfloat16) * 0.05)(D, N) / N ** 0.5),
        "C_imag": _w((lambda *s: torch.randn(*s, dtype=torch.bfloat16) * 0.05)(D, N) / N ** 0.5),
        "log_dt": _w((lambda *s: torch.randn(*s, dtype=torch.bfloat16) * 0.05)(D) * 0.5 - 4.0),
        "D_skip": _w((lambda *s: torch.randn(*s, dtype=torch.bfloat16) * 0.05)(D)),
    }

def reference(u, log_A_real, A_imag, C_real, C_imag, log_dt, D_skip):
    L = u.shape[1]
    dt = torch.exp(log_dt)
    A = -torch.exp(log_A_real) + 1j * A_imag
    C = (C_real + 1j * C_imag) * dt[:, None]
    pos = (lambda x, dt: x.to(dt))(torch.arange(L), log_dt.dtype)
    P = torch.exp((A * dt[:, None])[:, :, None] * pos[None, None, :])
    K = 2.0 * torch.einsum("dn,dnl->dl", C, P).real
    L2 = 2 * L
    u_t = (lambda x, *d: x.permute(*d))(u, 0, 2, 1)
    Kf = (lambda x, *a, **k: torch.fft.rfft(x.float(), *a, **k))(K, L2)
    Uf = (lambda x, *a, **k: torch.fft.rfft(x.float(), *a, **k))(u_t, L2)
    y = (lambda x, *a, **k: torch.fft.irfft(x, *a, **k).to(torch.bfloat16))(Uf * Kf[None, :, :], L2)[:, :, :L]
    y = (lambda x, *d: x.permute(*d))(y, 0, 2, 1)
    return y + u * D_skip[None, None, :]
```

```asm
; @launch grid=(256,1,1) block=(512,1,1) lds=149504
.amdgcn_target "amdgcn-amd-amdhsa--gfx950"
.text
.globl standalone__ssm_conv_s4d__prompt_kernel
.p2align 8
.type standalone__ssm_conv_s4d__prompt_kernel,@function
standalone__ssm_conv_s4d__prompt_kernel:
    s_load_dwordx16 s[16:31], s[0:1], 0
    s_load_dwordx4 s[60:63], s[0:1], 64
    s_cmp_ge_u32 s2, 256
    s_cbranch_scc1 L_end
    s_and_b32 s12, s2, 7
    s_lshl_b32 s3, s12, 2
    s_lshr_b32 s101, 0x22202222, s3
    s_and_b32 s101, s101, 3
    s_lshr_b32 s14, s2, 7
    s_cmp_ge_u32 s14, s101
    s_cbranch_scc1 L_end
    s_lshr_b32 s12, 0xca806420, s3
    s_and_b32 s12, s12, 15
    s_getpc_b64 s[98:99]
L_pc:
    s_and_b32 s3, s2, 8
    s_lshl_b32 s3, s3, 4
    v_lshl_add_u32 v46, v0, 8, s3
    v_min_u32 v46, L_end-L_pc, v46
    global_load_dword v255, v46, s[98:99]
    s_lshl_b32 s12, s12, 6
    s_lshr_b32 s14, s2, 4
    s_lshl_b32 s14, s14, 3
    s_add_u32 s14, s14, s12
    s_lshl_b32 s35, s14, 8
    s_lshl_b32 s3, s3, 3
    s_add_u32 s3, s3, s35
    v_lshrrev_b32 v19, 6, v0
    v_and_b32 v1, 63, v0
    v_and_b32 v253, 64, v0
    v_readfirstlane_b32 s32, v19
    v_and_b32 v47, 0x180, v0
    v_lshl_add_u32 v253, v253, 3, v47
    v_lshl_add_u32 v47, v1, 1, s3
    v_add_u32 v253, v253, v47
    v_mov_b32 v36, 0
    v_mov_b32 v37, 0
    v_mov_b32 v38, 0
    v_mov_b32 v39, 0
    s_lshr_b32 s13, s2, 3
    s_xor_b32 s32, s32, 4
    s_and_b32 s15, s13, 1
    s_lshr_b32 s34, s32, 2
    s_xor_b32 s33, s15, s34
    s_lshl_b32 s33, s33, 1
    s_and_b32 s3, s32, 1
    s_add_u32 s33, s33, s3
    s_lshl_b32 s53, s3, 8
    s_mov_b32 s6, 1835008
    s_mov_b32 s7, 0x20000
    v_mul_u32_u24 v47, 1792, v1
    s_xor_b32 s3, s34, 1
    s_lshl_b32 s3, s3, 3
    s_and_b32 s47, s32, 3
    s_add_u32 s47, s47, s3
    s_mul_i32 s3, s47, 114688
    s_add_u32 s3, s3, s14
    v_add_u32 v2, s3, v47
    v_add_u32 v3, 458752, v2
    s_lshl_b32 s47, s47, 8
    s_lshl_b32 s46, s32, 8
    s_lshl_b32 s3, s13, 3
    s_add_u32 s3, s3, s32
    s_mul_i32 s3, s3, 7168
    s_and_b32 s101, s101, 1
    s_lshl_b32 s3, s3, s101
    s_lshl_b32 s101, s101, 3
    s_lshl_b32 s101, 0x200, s101
    s_sub_u32 s101, s101, 1
    s_add_u32 s3, s3, s12
    s_sub_u32 s3, s3, 896
    v_cmp_eq_u32 vcc, 0, v1
    v_lshrrev_b32 v48, 1, v47
    v_add_u32 v48, s3, v48
    v_subrev_u32 v49, 896, v2
    v_cndmask_b32 v48, v48, v49, vcc
    v_cmp_eq_u32 vcc, 63, v1
    v_subrev_u32 v50, 113792, v3
    v_mov_b32 v51, 0
    v_cndmask_b32 v252, v48, v50, vcc
    v_lshrrev_b32 v52, 7, v0
    v_and_b32 v53, 127, v0
    v_mul_u32_u24 v52, 4608, v52
    v_lshl_add_u32 v52, v53, 2, v52
    v_add_u32 v52, 134656, v52
    ds_write_b32 v52, v51
    v_lshrrev_b32 v54, 3, v53
    v_and_b32 v53, 7, v53
    v_mul_u32_u24 v54, 4160, v54
    v_lshl_add_u32 v54, v53, 2, v54
    ds_write_b32 v54, v51 offset:64000
    v_lshlrev_b32 v55, 2, v1
    v_add_u32 v55, 149232, v55
    v_mov_b32 v56, 0x3c00
    ds_write_b32 v55, v56
    v_and_b32 v46, 31, v1
    v_and_b32 v47, 32, v1
    v_lshrrev_b32 v47, 1, v47
    v_mul_u32_u24 v48, 2064, v46
    v_add3_u32 v41, v48, v47, s46
    v_cmp_eq_u32 vcc, 0, v46
    v_subrev_u32 v40, 2064, v41
    v_add_u32 v49, 149232, v47
    v_add_u32 v50, 16512, v41
    v_cndmask_b32 v40, v40, v49, vcc
    v_cmp_eq_u32 vcc, 8, v46
    s_mov_b32 m0, s46
    s_lshl_b32 s96, s14, 13
    s_add_u32 s96, s96, 1081344
    v_cndmask_b32 v41, v41, v50, vcc
    v_mov_b32 v247, s96
    s_mov_b32 s49, 0x3fb8aa3b
    s_mov_b32 s50, 0x32a57060
    s_mov_b32 s51, 0x3e22f983
    s_mov_b32 s52, 0x31dc9c88
    s_lshr_b32 s3, s32, 1
    s_lshl_b32 s59, s15, 2
    s_add_u32 s59, s3, s59
    s_lshl_b32 s100, s15, 5
    s_lshr_b32 s57, s53, 4
    s_add_u32 s100, s100, s57
    s_waitcnt lgkmcnt(0)
    global_load_short_d16_hi v36, v253, s[18:19]
    global_load_short_d16_hi v37, v253, s[20:21]
    s_load_dwordx2 s[36:37], s[26:27], s14
    s_load_dwordx2 s[38:39], s[28:29], s14
    s_mov_b32 s4, s16
    s_mov_b32 s5, s17
    s_barrier
    global_load_short_d16_hi v38, v253, s[22:23]
    global_load_short_d16_hi v39, v253, s[24:25]
    global_load_dword v248, v247, s[62:63] sc1
    s_mov_b32 exec_lo, s101
    s_mov_b32 exec_hi, 0x80000000
    s_barrier
    buffer_load_dwordx2 v[12:13], v252, s[4:7], 0 offen
    s_mov_b64 exec, -1
    s_barrier
    s_cmp_eq_u32 s34, 0
    s_cbranch_scc1 L_nou
    buffer_load_dwordx2 v[4:5], v2, s[4:7], 0 offen offset:0
    buffer_load_dwordx2 v[6:7], v2, s[4:7], 0 offen offset:896
    buffer_load_dwordx2 v[8:9], v3, s[4:7], 0 offen offset:0
L_nou:
    s_cmp_eq_u32 s59, 0
    s_cbranch_scc1 L_t0
    s_cmp_eq_u32 s59, 1
    s_cbranch_scc1 L_t1
    s_cmp_eq_u32 s59, 2
    s_cbranch_scc1 L_t2
    s_cmp_eq_u32 s59, 3
    s_cbranch_scc1 L_t3
    s_cmp_eq_u32 s59, 4
    s_cbranch_scc1 L_t4
    s_cmp_eq_u32 s59, 5
    s_cbranch_scc1 L_t5
    s_cmp_eq_u32 s59, 6
    s_cbranch_scc1 L_t6
    s_branch L_t7
L_tback:
    s_waitcnt lgkmcnt(0)
    s_lshr_b64 s[36:37], s[36:37], s100
    s_lshl_b32 s36, s36, 16
    v_mov_b32 v46, s36
    v_mul_f32 v47, s49, v46
    v_rndne_f32 v47, v47
    v_fma_f32 v48, v46, s49, -v47
    v_fma_f32 v48, v46, s50, v48
    v_exp_f32 v48, v48
    v_cvt_i32_f32 v47, v47
    v_ldexp_f32 v48, v48, v47
    v_cvt_pk_bf16_f32 v48, v48, v48
    v_and_b32 v44, 0xffff0000, v48
    v_mul_f32 v42, s49, v44
    s_waitcnt vmcnt(7)
    s_cmp_lg_u32 s34, 0
    s_cbranch_scc1 L_pw
    s_waitcnt vmcnt(4)
L_pw:
    v_mul_f32 v54, s49, v36
    v_exp_f32 v54, v54
    v_mul_f32 v55, v37, v44
    v_mul_f32 v56, s51, v55
    v_cvt_pk_bf16_f32 v54, v54, v54
    v_fma_f32 v57, v55, s51, -v56
    v_and_b32 v54, 0xffff0000, v54
    v_fma_f32 v57, v55, s52, v57
    v_mul_f32 v54, v54, v42
    v_rndne_f32 v58, v56
    v_sub_f32 v56, v56, v58
    v_exp_f32 v54, -v54
    v_add_f32 v56, v56, v57
    v_cos_f32 v50, v56
    v_sin_f32 v51, v56
    s_nop 0
    v_pk_mul_f32 v[50:51], v[50:51], v[54:55] op_sel_hi:[1,0]
    v_pk_mul_f32 v[52:53], v[50:51], v[50:51] op_sel:[0,0] op_sel_hi:[1,0]
    v_pk_fma_f32 v[52:53], v[50:51], v[50:51], v[52:53] op_sel:[1,1,0] op_sel_hi:[0,1,1] neg_lo:[1,0,0]
    v_pk_mul_f32 v[92:93], v[52:53], v[52:53] op_sel:[0,0] op_sel_hi:[1,0]
    v_pk_fma_f32 v[92:93], v[52:53], v[52:53], v[92:93] op_sel:[1,1,0] op_sel_hi:[0,1,1] neg_lo:[1,0,0]
    v_pk_mul_f32 v[46:47], v[92:93], v[92:93] op_sel:[0,0] op_sel_hi:[1,0]
    v_pk_fma_f32 v[46:47], v[92:93], v[92:93], v[46:47] op_sel:[1,1,0] op_sel_hi:[0,1,1] neg_lo:[1,0,0]
    v_cvt_pk_f16_f32 v20, v46, v47
    ds_write_addtid_b32 v20 offset:0
    v_pk_mul_f32 v[48:49], v[46:47], v[46:47] op_sel:[0,0] op_sel_hi:[1,0]
    v_pk_fma_f32 v[48:49], v[46:47], v[46:47], v[48:49] op_sel:[1,1,0] op_sel_hi:[0,1,1] neg_lo:[1,0,0]
    v_cvt_pk_f16_f32 v21, v48, v49
    ds_write_addtid_b32 v21 offset:2064
    v_pk_mul_f32 v[46:47], v[48:49], v[48:49] op_sel:[0,0] op_sel_hi:[1,0]
    v_pk_fma_f32 v[46:47], v[48:49], v[48:49], v[46:47] op_sel:[1,1,0] op_sel_hi:[0,1,1] neg_lo:[1,0,0]
    v_cvt_pk_f16_f32 v23, v46, v47
    ds_write_addtid_b32 v23 offset:6192
    v_pk_mul_f32 v[48:49], v[46:47], v[46:47] op_sel:[0,0] op_sel_hi:[1,0]
    v_pk_fma_f32 v[48:49], v[46:47], v[46:47], v[48:49] op_sel:[1,1,0] op_sel_hi:[0,1,1] neg_lo:[1,0,0]
    v_cvt_pk_f16_f32 v27, v48, v49
    ds_write_addtid_b32 v27 offset:14448
    v_pk_mul_f32 v[46:47], v[48:49], v[48:49] op_sel:[0,0] op_sel_hi:[1,0]
    v_pk_fma_f32 v[46:47], v[48:49], v[48:49], v[46:47] op_sel:[1,1,0] op_sel_hi:[0,1,1] neg_lo:[1,0,0]
    v_cvt_pk_f16_f32 v35, v46, v47
    ds_write_addtid_b32 v35 offset:30960
    v_pk_mul_f16 v22, v20, v21 op_sel:[0,0] op_sel_hi:[1,0]
    v_pk_fma_f16 v22, v20, v21, v22 op_sel:[1,1,0] op_sel_hi:[0,1,1] neg_lo:[1,0,0]
    v_pk_mul_f16 v24, v20, v23 op_sel:[0,0] op_sel_hi:[1,0]
    ds_write_addtid_b32 v22 offset:4128
    v_pk_fma_f16 v24, v20, v23, v24 op_sel:[1,1,0] op_sel_hi:[0,1,1] neg_lo:[1,0,0]
    v_pk_mul_f16 v25, v21, v23 op_sel:[0,0] op_sel_hi:[1,0]
    v_pk_fma_f16 v25, v21, v23, v25 op_sel:[1,1,0] op_sel_hi:[0,1,1] neg_lo:[1,0,0]
    ds_write_addtid_b32 v24 offset:8256
    v_pk_mul_f16 v26, v22, v23 op_sel:[0,0] op_sel_hi:[1,0]
    v_pk_fma_f16 v26, v22, v23, v26 op_sel:[1,1,0] op_sel_hi:[0,1,1] neg_lo:[1,0,0]
    v_pk_mul_f16 v28, v20, v27 op_sel:[0,0] op_sel_hi:[1,0]
    ds_write_addtid_b32 v25 offset:10320
    v_pk_fma_f16 v28, v20, v27, v28 op_sel:[1,1,0] op_sel_hi:[0,1,1] neg_lo:[1,0,0]
    v_pk_mul_f16 v29, v21, v27 op_sel:[0,0] op_sel_hi:[1,0]
    v_pk_fma_f16 v29, v21, v27, v29 op_sel:[1,1,0] op_sel_hi:[0,1,1] neg_lo:[1,0,0]
    s_waitcnt vmcnt(5)
    s_cmp_lg_u32 s34, 0
    s_cbranch_scc1 L_ld1
    s_waitcnt vmcnt(2)
L_ld1:
    ds_write_addtid_b32 v26 offset:12384
    v_pk_mul_f16 v30, v22, v27 op_sel:[0,0] op_sel_hi:[1,0]
    v_pk_fma_f16 v30, v22, v27, v30 op_sel:[1,1,0] op_sel_hi:[0,1,1] neg_lo:[1,0,0]
    v_pk_mul_f16 v31, v23, v27 op_sel:[0,0] op_sel_hi:[1,0]
    ds_write_addtid_b32 v28 offset:16512
    v_pk_fma_f16 v31, v23, v27, v31 op_sel:[1,1,0] op_sel_hi:[0,1,1] neg_lo:[1,0,0]
    v_pk_mul_f16 v32, v24, v27 op_sel:[0,0] op_sel_hi:[1,0]
    v_pk_fma_f16 v32, v24, v27, v32 op_sel:[1,1,0] op_sel_hi:[0,1,1] neg_lo:[1,0,0]
    ds_write_addtid_b32 v29 offset:18576
    v_pk_mul_f16 v33, v25, v27 op_sel:[0,0] op_sel_hi:[1,0]
    v_pk_fma_f16 v33, v25, v27, v33 op_sel:[1,1,0] op_sel_hi:[0,1,1] neg_lo:[1,0,0]
    v_pk_mul_f16 v34, v26, v27 op_sel:[0,0] op_sel_hi:[1,0]
    ds_write_addtid_b32 v30 offset:20640
    v_pk_fma_f16 v34, v26, v27, v34 op_sel:[1,1,0] op_sel_hi:[0,1,1] neg_lo:[1,0,0]
    v_pk_mul_f16 v80, v20, v35 op_sel:[0,0] op_sel_hi:[1,0]
    v_pk_fma_f16 v80, v20, v35, v80 op_sel:[1,1,0] op_sel_hi:[0,1,1] neg_lo:[1,0,0]
    ds_write_addtid_b32 v31 offset:22704
    v_pk_mul_f16 v81, v21, v35 op_sel:[0,0] op_sel_hi:[1,0]
    v_pk_fma_f16 v81, v21, v35, v81 op_sel:[1,1,0] op_sel_hi:[0,1,1] neg_lo:[1,0,0]
    v_pk_mul_f16 v82, v22, v35 op_sel:[0,0] op_sel_hi:[1,0]
    ds_write_addtid_b32 v32 offset:24768
    v_pk_fma_f16 v82, v22, v35, v82 op_sel:[1,1,0] op_sel_hi:[0,1,1] neg_lo:[1,0,0]
    v_pk_mul_f16 v83, v23, v35 op_sel:[0,0] op_sel_hi:[1,0]
    v_pk_fma_f16 v83, v23, v35, v83 op_sel:[1,1,0] op_sel_hi:[0,1,1] neg_lo:[1,0,0]
    ds_write_addtid_b32 v33 offset:26832
    v_pk_mul_f16 v84, v24, v35 op_sel:[0,0] op_sel_hi:[1,0]
    v_pk_fma_f16 v84, v24, v35, v84 op_sel:[1,1,0] op_sel_hi:[0,1,1] neg_lo:[1,0,0]
    v_pk_mul_f16 v85, v25, v35 op_sel:[0,0] op_sel_hi:[1,0]
    ds_write_addtid_b32 v34 offset:28896
    v_pk_fma_f16 v85, v25, v35, v85 op_sel:[1,1,0] op_sel_hi:[0,1,1] neg_lo:[1,0,0]
    v_pk_mul_f16 v86, v26, v35 op_sel:[0,0] op_sel_hi:[1,0]
    v_pk_fma_f16 v86, v26, v35, v86 op_sel:[1,1,0] op_sel_hi:[0,1,1] neg_lo:[1,0,0]
    ds_write_addtid_b32 v80 offset:33024
    v_pk_mul_f16 v87, v27, v35 op_sel:[0,0] op_sel_hi:[1,0]
    v_pk_fma_f16 v87, v27, v35, v87 op_sel:[1,1,0] op_sel_hi:[0,1,1] neg_lo:[1,0,0]
    v_pk_mul_f16 v80, v28, v35 op_sel:[0,0] op_sel_hi:[1,0]
    ds_write_addtid_b32 v81 offset:35088
    v_pk_fma_f16 v80, v28, v35, v80 op_sel:[1,1,0] op_sel_hi:[0,1,1] neg_lo:[1,0,0]
    v_pk_mul_f16 v81, v29, v35 op_sel:[0,0] op_sel_hi:[1,0]
    v_pk_fma_f16 v81, v29, v35, v81 op_sel:[1,1,0] op_sel_hi:[0,1,1] neg_lo:[1,0,0]
    ds_write_addtid_b32 v82 offset:37152
    v_pk_mul_f16 v82, v30, v35 op_sel:[0,0] op_sel_hi:[1,0]
    v_pk_fma_f16 v82, v30, v35, v82 op_sel:[1,1,0] op_sel_hi:[0,1,1] neg_lo:[1,0,0]
    v_and_b32 v45, 0x7fffffff, v38
    ds_write_addtid_b32 v83 offset:39216
    v_pk_mul_f16 v83, v31, v35 op_sel:[0,0] op_sel_hi:[1,0]
    v_pk_fma_f16 v83, v31, v35, v83 op_sel:[1,1,0] op_sel_hi:[0,1,1] neg_lo:[1,0,0]
    v_and_b32 v79, 0x7fffffff, v39
    ds_write_addtid_b32 v84 offset:41280
    v_pk_mul_f16 v84, v32, v35 op_sel:[0,0] op_sel_hi:[1,0]
    v_pk_fma_f16 v84, v32, v35, v84 op_sel:[1,1,0] op_sel_hi:[0,1,1] neg_lo:[1,0,0]
    v_max_u32 v45, v45, v79
    ds_write_addtid_b32 v85 offset:43344
    v_pk_mul_f16 v85, v33, v35 op_sel:[0,0] op_sel_hi:[1,0]
    v_pk_fma_f16 v85, v33, v35, v85 op_sel:[1,1,0] op_sel_hi:[0,1,1] neg_lo:[1,0,0]
    v_max_u32_dpp v45, v45, v45 row_shr:1 row_mask:0xf bank_mask:0xf
    ds_write_addtid_b32 v86 offset:45408
    v_pk_mul_f16 v86, v34, v35 op_sel:[0,0] op_sel_hi:[1,0]
    v_pk_fma_f16 v86, v34, v35, v86 op_sel:[1,1,0] op_sel_hi:[0,1,1] neg_lo:[1,0,0]
    v_max_u32_dpp v45, v45, v45 row_shr:2 row_mask:0xf bank_mask:0xf
    ds_write_addtid_b32 v87 offset:47472
    v_pk_mul_f32 v[48:49], v[46:47], v[46:47] op_sel:[0,0] op_sel_hi:[1,0]
    v_max_u32_dpp v45, v45, v45 row_shr:4 row_mask:0xf bank_mask:0xf
    v_pk_fma_f32 v[48:49], v[46:47], v[46:47], v[48:49] op_sel:[1,1,0] op_sel_hi:[0,1,1] neg_lo:[1,0,0]
    ds_write_addtid_b32 v80 offset:49536
    v_max_u32_dpp v45, v45, v45 row_shr:8 row_mask:0xf bank_mask:0xf
    v_cvt_pk_f16_f32 v99, v48, v49
    v_pk_mul_f32 v[46:47], v[48:49], v[48:49] op_sel:[0,0] op_sel_hi:[1,0]
    ds_write_addtid_b32 v81 offset:51600
    v_max_u32_dpp v45, v45, v45 row_bcast:15 row_mask:0xa bank_mask:0xf
    v_pk_fma_f32 v[46:47], v[48:49], v[48:49], v[46:47] op_sel:[1,1,0] op_sel_hi:[0,1,1] neg_lo:[1,0,0]
    v_cvt_pk_f16_f32 v100, v46, v47
    ds_write_addtid_b32 v82 offset:53664
    v_max_u32_dpp v45, v45, v45 row_bcast:31 row_mask:0xc bank_mask:0xf
    v_pk_mul_f32 v[48:49], v[46:47], v[46:47] op_sel:[0,0] op_sel_hi:[1,0]
    v_readlane_b32 s57, v45, 63
    ds_write_addtid_b32 v83 offset:55728
    s_lshr_b32 s57, s57, 23
    s_max_u32 s57, s57, 16
    s_sub_u32 s56, 267, s57
    s_lshl_b32 s56, s56, 23
    v_pk_mul_f32 v[94:95], v[38:39], s[56:57] op_sel_hi:[1,0]
    v_cvt_pk_f16_f32 v66, v94, -v95
    v_pk_mul_f16 v74, v66, v99 op_sel:[0,0] op_sel_hi:[1,0]
    s_sub_u32 s54, s57, 12
    s_lshl_b32 s54, s54, 23
    ds_write_addtid_b32 v84 offset:57792
    v_pk_fma_f16 v74, v66, v99, v74 op_sel:[1,1,0] op_sel_hi:[0,1,1] neg_hi:[1,0,0]
    v_pk_mul_f16 v76, v66, v100 op_sel:[0,0] op_sel_hi:[1,0]
    v_pk_fma_f16 v76, v66, v100, v76 op_sel:[1,1,0] op_sel_hi:[0,1,1] neg_hi:[1,0,0]
    ds_write_addtid_b32 v85 offset:59856
    v_pk_fma_f32 v[48:49], v[46:47], v[46:47], v[48:49] op_sel:[1,1,0] op_sel_hi:[0,1,1] neg_lo:[1,0,0]
    v_cvt_pk_f16_f32 v101, v48, v49
    v_pk_mul_f16 v78, v66, v101 op_sel:[0,0] op_sel_hi:[1,0]
    s_cmp_eq_u32 s34, 0
    s_cbranch_scc1 L_ld2
    buffer_load_dwordx2 v[10:11], v3, s[4:7], 0 offen offset:896
L_ld2:
    ds_write_addtid_b32 v86 offset:61920
    v_pk_fma_f16 v78, v66, v101, v78 op_sel:[1,1,0] op_sel_hi:[0,1,1] neg_hi:[1,0,0]
    v_pk_mul_f16 v77, v74, v100 op_sel:[0,0] op_sel_hi:[1,0]
    v_pk_fma_f16 v77, v74, v100, v77 op_sel:[1,1,0] op_sel_hi:[0,1,1] neg_hi:[1,0,0]
    ds_read_b128 v[128:131], v40 offset:0
    v_pk_mul_f16 v87, v74, v101 op_sel:[0,0] op_sel_hi:[1,0]
    v_pk_fma_f16 v87, v74, v101, v87 op_sel:[1,1,0] op_sel_hi:[0,1,1] neg_hi:[1,0,0]
    v_pk_mul_f16 v80, v76, v101 op_sel:[0,0] op_sel_hi:[1,0]
    ds_read_b128 v[132:135], v40 offset:32
    v_pk_fma_f16 v80, v76, v101, v80 op_sel:[1,1,0] op_sel_hi:[0,1,1] neg_hi:[1,0,0]
    v_pk_mul_f16 v81, v77, v101 op_sel:[0,0] op_sel_hi:[1,0]
    v_pk_fma_f16 v81, v77, v101, v81 op_sel:[1,1,0] op_sel_hi:[0,1,1] neg_hi:[1,0,0]
    ds_read_b128 v[136:139], v40 offset:64
    v_pk_mul_f16 v82, v78, v101 op_sel:[0,0] op_sel_hi:[1,0]
    v_pk_fma_f16 v82, v78, v101, v82 op_sel:[1,1,0] op_sel_hi:[0,1,1] neg_hi:[1,0,0]
    v_cvt_pk_f16_f32 v96, v50, v51
    ds_read_b128 v[140:143], v40 offset:96
    v_pk_mul_f16 v67, v66, v96 op_sel:[0,0] op_sel_hi:[1,0]
    v_pk_fma_f16 v67, v66, v96, v67 op_sel:[1,1,0] op_sel_hi:[0,1,1] neg_hi:[1,0,0]
    v_cvt_pk_f16_f32 v97, v52, v53
    ds_read_b128 v[144:147], v40 offset:128
    v_pk_mul_f16 v68, v66, v97 op_sel:[0,0] op_sel_hi:[1,0]
    v_pk_fma_f16 v68, v66, v97, v68 op_sel:[1,1,0] op_sel_hi:[0,1,1] neg_hi:[1,0,0]
    v_pk_mul_f16 v69, v67, v97 op_sel:[0,0] op_sel_hi:[1,0]
    ds_read_b128 v[148:151], v40 offset:160
    v_pk_fma_f16 v69, v67, v97, v69 op_sel:[1,1,0] op_sel_hi:[0,1,1] neg_hi:[1,0,0]
    v_cvt_pk_f16_f32 v98, v92, v93
    v_pk_mul_f16 v70, v66, v98 op_sel:[0,0] op_sel_hi:[1,0]
    ds_read_b128 v[152:155], v40 offset:192
    v_pk_fma_f16 v70, v66, v98, v70 op_sel:[1,1,0] op_sel_hi:[0,1,1] neg_hi:[1,0,0]
    v_pk_mul_f16 v71, v67, v98 op_sel:[0,0] op_sel_hi:[1,0]
    v_pk_fma_f16 v71, v67, v98, v71 op_sel:[1,1,0] op_sel_hi:[0,1,1] neg_hi:[1,0,0]
    ds_read_b128 v[156:159], v40 offset:224
    v_pk_mul_f16 v72, v68, v98 op_sel:[0,0] op_sel_hi:[1,0]
    v_pk_fma_f16 v72, v68, v98, v72 op_sel:[1,1,0] op_sel_hi:[0,1,1] neg_hi:[1,0,0]
    v_pk_mul_f16 v73, v69, v98 op_sel:[0,0] op_sel_hi:[1,0]
    ds_write_addtid_b32 v66 offset:0
    v_pk_fma_f16 v73, v69, v98, v73 op_sel:[1,1,0] op_sel_hi:[0,1,1] neg_hi:[1,0,0]
    v_pk_mul_f16 v83, v68, v99 op_sel:[0,0] op_sel_hi:[1,0]
    v_pk_fma_f16 v83, v68, v99, v83 op_sel:[1,1,0] op_sel_hi:[0,1,1] neg_hi:[1,0,0]
    ds_write_addtid_b32 v74 offset:24768
    v_pk_mul_f16 v75, v70, v99 op_sel:[0,0] op_sel_hi:[1,0]
    v_pk_fma_f16 v75, v70, v99, v75 op_sel:[1,1,0] op_sel_hi:[0,1,1] neg_hi:[1,0,0]
    v_pk_mul_f16 v84, v72, v99 op_sel:[0,0] op_sel_hi:[1,0]
    ds_write_addtid_b32 v76 offset:33024
    v_pk_fma_f16 v84, v72, v99, v84 op_sel:[1,1,0] op_sel_hi:[0,1,1] neg_hi:[1,0,0]
    v_pk_mul_f16 v85, v70, v100 op_sel:[0,0] op_sel_hi:[1,0]
    v_pk_fma_f16 v85, v70, v100, v85 op_sel:[1,1,0] op_sel_hi:[0,1,1] neg_hi:[1,0,0]
    ds_write_addtid_b32 v78 offset:37152
    v_pk_mul_f16 v86, v75, v100 op_sel:[0,0] op_sel_hi:[1,0]
    v_pk_fma_f16 v86, v75, v100, v86 op_sel:[1,1,0] op_sel_hi:[0,1,1] neg_hi:[1,0,0]
    v_mul_f32 v43, s54, v44
    ds_write_addtid_b32 v77 offset:41280
    ds_write_addtid_b32 v87 offset:45408
    ds_write_addtid_b32 v80 offset:39216
    ds_write_addtid_b32 v81 offset:47472
    ds_write_addtid_b32 v82 offset:49536
    ds_write_addtid_b32 v67 offset:2064
    ds_write_addtid_b32 v68 offset:4128
    ds_write_addtid_b32 v69 offset:6192
    ds_write_addtid_b32 v70 offset:8256
    ds_write_addtid_b32 v71 offset:10320
    ds_write_addtid_b32 v72 offset:12384
    ds_write_addtid_b32 v73 offset:14448
    ds_write_addtid_b32 v83 offset:26832
    ds_write_addtid_b32 v75 offset:28896
    ds_write_addtid_b32 v84 offset:30960
    ds_write_addtid_b32 v85 offset:35088
    ds_write_addtid_b32 v86 offset:43344
    ds_read_b128 v[192:195], v41 offset:0
    ds_read_b128 v[196:199], v41 offset:32
    ds_read_b128 v[200:203], v41 offset:64
    ds_read_b128 v[204:207], v41 offset:96
    ds_read_b128 v[208:211], v41 offset:128
    ds_read_b128 v[212:215], v41 offset:160
    ds_read_b128 v[216:219], v41 offset:192
    ds_read_b128 v[220:223], v41 offset:224
    s_cmp_eq_u32 s59, 0
    s_cbranch_scc1 L_cv0
    s_cmp_eq_u32 s59, 1
    s_cbranch_scc1 L_cv1
    s_cmp_eq_u32 s59, 2
    s_cbranch_scc1 L_cv2
    s_cmp_eq_u32 s59, 3
    s_cbranch_scc1 L_cv3
    s_cmp_eq_u32 s59, 4
    s_cbranch_scc1 L_cv4
    s_cmp_eq_u32 s59, 5
    s_cbranch_scc1 L_cv5
    s_cmp_eq_u32 s59, 6
    s_cbranch_scc1 L_cv6
    s_branch L_cv7
.p2align 6
L_t0:
    s_branch L_tback
    s_nop 0
L_cv0:
    s_setprio 0
    s_mul_i32 s48, s33, 4608
    s_add_u32 s48, s48, 130560
    v_and_b32 v46, 31, v1
    v_lshrrev_b32 v47, 5, v1
    v_lshlrev_b32 v250, 4, v46
    s_waitcnt lgkmcnt(7)
    v_mfma_f32_32x32x16_f16 v[224:239], v[192:195], v[128:131], 0
    v_lshl_add_u32 v250, v47, 3, v250
    s_add_u32 s3, s48, 4088
    v_sub_u32 v250, s3, v250
    v_lshlrev_b32 v251, 4, v1
    s_xor_b32 s3, s15, s34
    s_waitcnt lgkmcnt(6)
    v_mfma_f32_32x32x16_f16 v[224:239], v[196:199], v[132:135], v[224:239]
    s_lshl_b32 s3, s3, 2
    s_and_b32 s57, s32, 3
    s_add_u32 s3, s3, s57
    s_lshl_b32 s3, s3, 11
    s_add_u32 s3, s3, s96
    s_waitcnt lgkmcnt(5)
    v_mfma_f32_32x32x16_f16 v[224:239], v[200:203], v[136:139], v[224:239]
    s_sub_u32 s3, s3, 32768
    v_add_u32 v249, s3, v251
    s_add_u32 s3, s48, 1008
    v_sub_u32 v251, s3, v251
    v_and_b32 v46, 15, v1
    s_waitcnt lgkmcnt(4)
    v_mfma_f32_32x32x16_f16 v[224:239], v[204:207], v[140:143], v[224:239]
    v_and_b32 v47, 48, v1
    v_add_u32 v48, 1, v46
    v_and_b32 v49, 3, v48
    v_and_b32 v48, 28, v48
    v_mul_u32_u24 v49, 4160, v49
    s_waitcnt lgkmcnt(3)
    v_mfma_f32_32x32x16_f16 v[224:239], v[208:211], v[144:147], v[224:239]
    v_lshl_add_u32 v48, v48, 1, v47
    s_and_b32 s57, s32, 2
    s_lshl_b32 s57, s57, 7
    s_mul_i32 s3, s33, 16640
    s_add_u32 s3, s3, s57
    s_waitcnt lgkmcnt(2)
    v_mfma_f32_32x32x16_f16 v[224:239], v[212:215], v[148:151], v[224:239]
    s_add_u32 s3, s3, 64000
    v_add3_u32 v16, v48, v49, s3
    s_add_u32 s3, s48, s57
    s_add_u32 s3, s3, 480
    v_lshlrev_b32 v48, 5, v46
    s_waitcnt lgkmcnt(1)
    v_mfma_f32_32x32x16_f16 v[224:239], v[216:219], v[152:155], v[224:239]
    v_add_u32 v49, s3, v47
    v_sub_u32 v17, v49, v48
    s_mov_b32 s44, 0x05040100
    s_mov_b32 s45, 0x07060302
    s_waitcnt lgkmcnt(0)
    v_mfma_f32_32x32x16_f16 v[224:239], v[220:223], v[156:159], v[224:239]
    s_waitcnt vmcnt(1)
    v_readfirstlane_b32 s3, v248
    s_nop 1
    s_mul_i32 s3, s3, 0x9e3779b1
    s_add_u32 s3, s3, 0x7f4a7c15
    s_getreg_b32 s97, hwreg(HW_REG_XCC_ID)
    s_and_b32 s97, s97, 7
    s_add_u32 s97, s97, 1
    s_xor_b32 s97, s97, s3
    s_mov_b32 s99, s3
    v_mov_b32 v60, s97
    v_mul_f32 v232, v232, v43
    ds_write_addtid_b32 v232 offset:16512
    v_mul_f32 v233, v233, v43
    ds_write_addtid_b32 v233 offset:18576
    v_mul_f32 v234, v234, v43
    ds_write_addtid_b32 v234 offset:20640
    v_mul_f32 v235, v235, v43
    ds_write_addtid_b32 v235 offset:22704
    v_mul_f32 v236, v236, v43
    ds_write_addtid_b32 v236 offset:24768
    s_mov_b32 m0, s53
    s_waitcnt lgkmcnt(0)
    s_setprio 2
    s_barrier
    ds_read_addtid_b32 v160 offset:512
    ds_read_addtid_b32 v161 offset:2576
    ds_read_addtid_b32 v162 offset:4640
    ds_read_addtid_b32 v163 offset:6704
    ds_read_addtid_b32 v164 offset:8768
    ds_read_addtid_b32 v165 offset:10832
    ds_read_addtid_b32 v166 offset:12896
    ds_read_addtid_b32 v167 offset:14960
    ds_read_addtid_b32 v168 offset:1024
    ds_read_addtid_b32 v169 offset:3088
    ds_read_addtid_b32 v170 offset:5152
    ds_read_addtid_b32 v171 offset:7216
    ds_read_addtid_b32 v172 offset:9280
    ds_read_addtid_b32 v173 offset:11344
    ds_read_addtid_b32 v174 offset:13408
    ds_read_addtid_b32 v175 offset:15472
    ds_read_addtid_b32 v176 offset:1536
    ds_read_addtid_b32 v177 offset:3600
    ds_read_addtid_b32 v178 offset:5664
    ds_read_addtid_b32 v179 offset:7728
    ds_read_addtid_b32 v180 offset:9792
    ds_read_addtid_b32 v181 offset:11856
    ds_read_addtid_b32 v182 offset:13920
    ds_read_addtid_b32 v183 offset:15984
    s_mov_b32 m0, s46
    v_mov_b32 v187, v60
    v_mov_b32 v189, v60
    s_waitcnt lgkmcnt(15)
    v_fma_f32 v224, v224, v43, v160
    v_fma_f32 v225, v225, v43, v161
    v_fma_f32 v226, v226, v43, v162
    v_fma_f32 v227, v227, v43, v163
    v_fma_f32 v228, v228, v43, v164
    v_fma_f32 v229, v229, v43, v165
    v_fma_f32 v230, v230, v43, v166
    v_fma_f32 v231, v231, v43, v167
    s_waitcnt lgkmcnt(8)
    v_add_f32 v224, v224, v168
    v_add_f32 v225, v225, v169
    v_add_f32 v226, v226, v170
    v_add_f32 v227, v227, v171
    v_add_f32 v228, v228, v172
    v_add_f32 v229, v229, v173
    v_add_f32 v230, v230, v174
    v_add_f32 v231, v231, v175
    s_waitcnt lgkmcnt(0)
    v_add_f32 v224, v224, v176
    v_add_f32 v225, v225, v177
    v_add_f32 v226, v226, v178
    v_add_f32 v227, v227, v179
    v_add_f32 v228, v228, v180
    v_add_f32 v229, v229, v181
    v_add_f32 v230, v230, v182
    v_add_f32 v231, v231, v183
    v_cvt_pk_bf16_f32 v186, v228, v229
    v_cvt_pk_bf16_f32 v190, v230, v231
    v_cvt_pk_bf16_f32 v184, v224, v225
    v_mov_b32 v188, v186
    v_cvt_pk_bf16_f32 v185, v226, v227
    v_permlane32_swap_b32 v190, v186
    global_store_dwordx4 v249, v[184:187], s[62:63]
    s_mov_b64 exec, 1
    global_store_dwordx2 v249, v[188:189], s[62:63] offset:1024
    s_mov_b64 exec, -1
    buffer_load_dwordx2 v[4:5], v2, s[4:7], 0 offen offset:0
    v_cvt_pk_bf16_f32 v240, v227, v226
    v_cvt_pk_bf16_f32 v241, v225, v224
    v_mov_b32_dpp v242, v228 wave_rol:1 row_mask:0xf bank_mask:0xf
    ds_write_b64 v250, v[240:241]
    v_cvt_pk_bf16_f32 v245, v230, v230
    v_cvt_pk_bf16_f32 v246, v230, v229
    v_cvt_pk_bf16_f32 v247, v228, v228
    v_cvt_pk_bf16_f32 v244, v242, v231
    s_mov_b32 exec_lo, 0
    ds_write_b128 v251, v[244:247] offset:3072
    s_mov_b32 exec_lo, -1
    s_waitcnt lgkmcnt(0)
    s_setprio 0
    s_barrier
    ds_read_b64 v[64:65], v16 offset:0
    ds_read_b64 v[66:67], v16 offset:8
    ds_read_b128 v[68:71], v17 offset:3584
    ds_read_b64 v[72:73], v16 offset:64
    ds_read_b64 v[74:75], v16 offset:72
    ds_read_b128 v[76:79], v17 offset:3648
    ds_read_b64 v[80:81], v16 offset:128
    ds_read_b64 v[82:83], v16 offset:136
    ds_read_b128 v[84:87], v17 offset:3712
    ds_read_b64 v[88:89], v16 offset:192
    ds_read_b64 v[90:91], v16 offset:200
    ds_read_b128 v[92:95], v17 offset:3776
    ds_read_b128 v[96:99], v17 offset:2560
    ds_read_b128 v[100:103], v17 offset:2624
    ds_read_b128 v[104:107], v17 offset:2688
    ds_read_b128 v[108:111], v17 offset:2752
    s_waitcnt lgkmcnt(13)
    v_mfma_f32_16x16x32_bf16 v[28:31], v[68:71], v[64:67], 0
    ds_read_b64 v[112:113], v16 offset:512
    s_waitcnt lgkmcnt(11)
    v_mfma_f32_16x16x32_bf16 v[28:31], v[76:79], v[72:75], v[28:31]
    ds_read_b64 v[114:115], v16 offset:520
    ds_read_b128 v[116:119], v17 offset:3072
    s_waitcnt lgkmcnt(10)
    v_mfma_f32_16x16x32_bf16 v[28:31], v[84:87], v[80:83], v[28:31]
    ds_read_b64 v[120:121], v16 offset:576
    ds_read_b64 v[122:123], v16 offset:584
    ds_read_b128 v[124:127], v17 offset:3136
    buffer_load_dwordx2 v[6:7], v2, s[4:7], 0 offen offset:896
    s_waitcnt lgkmcnt(10)
    v_mfma_f32_16x16x32_bf16 v[28:31], v[92:95], v[88:91], v[28:31]
    ds_read_b64 v[128:129], v16 offset:640
    ds_read_b64 v[130:131], v16 offset:648
    ds_read_b128 v[132:135], v17 offset:3200
    s_waitcnt lgkmcnt(12)
    v_mfma_f32_16x16x32_bf16 v[32:35], v[96:99], v[64:67], 0
    ds_read_b64 v[136:137], v16 offset:704
    ds_read_b64 v[138:139], v16 offset:712
    ds_read_b128 v[140:143], v17 offset:3264
    s_waitcnt lgkmcnt(14)
    v_mfma_f32_16x16x32_bf16 v[32:35], v[100:103], v[72:75], v[32:35]
    ds_read_b64 v[144:145], v16 offset:1024
    ds_read_b64 v[146:147], v16 offset:1032
    s_waitcnt lgkmcnt(15)
    v_mfma_f32_16x16x32_bf16 v[32:35], v[104:107], v[80:83], v[32:35]
    ds_read_b64 v[148:149], v16 offset:1088
    ds_read_b64 v[150:151], v16 offset:1096
    ds_write_addtid_b32 v28 offset:0
    s_waitcnt lgkmcnt(15)
    v_mfma_f32_16x16x32_bf16 v[32:35], v[108:111], v[88:91], v[32:35]
    ds_read_b64 v[152:153], v16 offset:1152
    ds_read_b64 v[154:155], v16 offset:1160
    ds_write_addtid_b32 v29 offset:8256
    s_waitcnt lgkmcnt(15)
    v_mfma_f32_16x16x32_bf16 v[32:35], v[116:119], v[112:115], v[32:35]
    ds_read_b64 v[156:157], v16 offset:1216
    ds_read_b64 v[158:159], v16 offset:1224
    ds_write_addtid_b32 v30 offset:16512
    s_waitcnt lgkmcnt(15)
    v_mfma_f32_16x16x32_bf16 v[32:35], v[124:127], v[120:123], v[32:35]
    ds_read_b128 v[160:163], v17 offset:512
    ds_write_addtid_b32 v31 offset:24768
    s_waitcnt lgkmcnt(15)
    v_mfma_f32_16x16x32_bf16 v[32:35], v[132:135], v[128:131], v[32:35]
    ds_read_b128 v[164:167], v17 offset:576
    s_waitcnt lgkmcnt(14)
    v_mfma_f32_16x16x32_bf16 v[32:35], v[140:143], v[136:139], v[32:35]
    ds_read_b128 v[168:171], v17 offset:640
    buffer_load_dwordx2 v[8:9], v3, s[4:7], 0 offen offset:0
    s_waitcnt lgkmcnt(13)
    v_mfma_f32_16x16x32_bf16 v[32:35], v[68:71], v[144:147], v[32:35]
    ds_read_b128 v[172:175], v17 offset:704
    s_waitcnt lgkmcnt(12)
    v_mfma_f32_16x16x32_bf16 v[32:35], v[76:79], v[148:151], v[32:35]
    ds_read_b128 v[176:179], v17 offset:1024
    s_waitcnt lgkmcnt(10)
    v_mfma_f32_16x16x32_bf16 v[32:35], v[84:87], v[152:155], v[32:35]
    ds_read_b128 v[180:183], v17 offset:1088
    s_waitcnt lgkmcnt(8)
    v_mfma_f32_16x16x32_bf16 v[32:35], v[92:95], v[156:159], v[32:35]
    ds_read_b128 v[184:187], v17 offset:1152
    s_waitcnt lgkmcnt(7)
    v_mfma_f32_16x16x32_bf16 v[36:39], v[160:163], v[64:67], 0
    ds_read_b128 v[188:191], v17 offset:1216
    s_waitcnt lgkmcnt(6)
    v_mfma_f32_16x16x32_bf16 v[36:39], v[164:167], v[72:75], v[36:39]
    ds_read_b128 v[192:195], v17 offset:1536
    s_waitcnt lgkmcnt(6)
    v_mfma_f32_16x16x32_bf16 v[36:39], v[168:171], v[80:83], v[36:39]
    ds_read_b128 v[196:199], v17 offset:1600
    ds_write_addtid_b32 v32 offset:2064
    s_waitcnt lgkmcnt(7)
    v_mfma_f32_16x16x32_bf16 v[36:39], v[172:175], v[88:91], v[36:39]
    ds_read_b128 v[200:203], v17 offset:1664
    ds_write_addtid_b32 v33 offset:10320
    s_waitcnt lgkmcnt(8)
    v_mfma_f32_16x16x32_bf16 v[36:39], v[176:179], v[112:115], v[36:39]
    ds_read_b128 v[204:207], v17 offset:1728
    ds_write_addtid_b32 v34 offset:18576
    s_waitcnt lgkmcnt(9)
    v_mfma_f32_16x16x32_bf16 v[36:39], v[180:183], v[120:123], v[36:39]
    ds_read_b64 v[208:209], v16 offset:1536
    ds_read_b64 v[210:211], v16 offset:1544
    ds_read_b128 v[212:215], v17 offset:2048
    ds_write_addtid_b32 v35 offset:26832
    s_waitcnt lgkmcnt(12)
    v_mfma_f32_16x16x32_bf16 v[36:39], v[184:187], v[128:131], v[36:39]
    ds_read_b64 v[216:217], v16 offset:1600
    ds_read_b64 v[218:219], v16 offset:1608
    ds_read_b128 v[220:223], v17 offset:2112
    s_waitcnt lgkmcnt(14)
    v_mfma_f32_16x16x32_bf16 v[36:39], v[188:191], v[136:139], v[36:39]
    ds_read_b64 v[224:225], v16 offset:1664
    ds_read_b64 v[226:227], v16 offset:1672
    ds_read_b128 v[228:231], v17 offset:2176
    s_waitcnt lgkmcnt(15)
    v_mfma_f32_16x16x32_bf16 v[36:39], v[192:195], v[144:147], v[36:39]
    ds_read_b64 v[232:233], v16 offset:1728
    ds_read_b64 v[234:235], v16 offset:1736
    ds_read_b128 v[236:239], v17 offset:2240
    v_mfma_f32_16x16x32_bf16 v[36:39], v[196:199], v[148:151], v[36:39]
    ds_read_b128 v[240:243], v17 offset:0
    s_waitcnt lgkmcnt(15)
    v_mfma_f32_16x16x32_bf16 v[36:39], v[200:203], v[152:155], v[36:39]
    ds_read_b128 v[244:247], v17 offset:64
    v_mfma_f32_16x16x32_bf16 v[36:39], v[204:207], v[156:159], v[36:39]
    ds_read_b128 v[76:79], v17 offset:128
    s_waitcnt lgkmcnt(13)
    v_mfma_f32_16x16x32_bf16 v[36:39], v[212:215], v[208:211], v[36:39]
    ds_read_b128 v[84:87], v17 offset:192
    s_waitcnt lgkmcnt(10)
    v_mfma_f32_16x16x32_bf16 v[36:39], v[220:223], v[216:219], v[36:39]
    s_waitcnt lgkmcnt(7)
    v_mfma_f32_16x16x32_bf16 v[36:39], v[228:231], v[224:227], v[36:39]
    s_waitcnt lgkmcnt(4)
    v_mfma_f32_16x16x32_bf16 v[36:39], v[236:239], v[232:235], v[36:39]
    v_bfe_u32 v46, v1, 3, 2
    v_mul_u32_u24 v46, 8256, v46
    v_and_b32 v47, 32, v1
    v_lshl_add_u32 v46, v47, 1, v46
    v_and_b32 v47, 7, v1
    v_lshl_add_u32 v46, v47, 3, v46
    s_lshr_b32 s3, s53, 1
    v_add_u32 v18, s3, v46
    s_add_u32 s3, s53, 64032
    v_lshl_add_u32 v19, v1, 2, s3
    v_mul_u32_u24 v47, 1792, v1
    s_mul_i32 s3, s53, 448
    s_add_u32 s3, s3, s14
    v_add_u32 v0, s3, v47
    s_mov_b32 s8, s30
    s_mov_b32 s9, s31
    s_mov_b32 s10, 1835008
    s_mov_b32 s11, 0x20000
    s_lshl_b32 s40, s38, 16
    s_and_b32 s41, s38, 0xffff0000
    s_lshl_b32 s42, s39, 16
    s_and_b32 s43, s39, 0xffff0000
    ds_read_b32 v21, v19 offset:0
    ds_read_b32 v23, v19 offset:16640
    ds_read_b32 v25, v19 offset:33280
    ds_read_b32 v27, v19 offset:49920
    s_waitcnt lgkmcnt(3)
    v_lshlrev_b32 v20, 16, v21
    v_and_b32 v21, 0xffff0000, v21
    v_mul_f32 v20, s40, v20
    v_mul_f32 v21, s40, v21
    v_cvt_pk_bf16_f32 v21, v20, v21
    v_lshlrev_b32 v20, 16, v21
    v_and_b32 v21, 0xffff0000, v21
    s_waitcnt lgkmcnt(2)
    v_lshlrev_b32 v22, 16, v23
    v_and_b32 v23, 0xffff0000, v23
    v_mul_f32 v22, s41, v22
    v_mul_f32 v23, s41, v23
    v_cvt_pk_bf16_f32 v23, v22, v23
    v_lshlrev_b32 v22, 16, v23
    v_and_b32 v23, 0xffff0000, v23
    s_waitcnt lgkmcnt(1)
    v_lshlrev_b32 v24, 16, v25
    v_and_b32 v25, 0xffff0000, v25
    v_mul_f32 v24, s42, v24
    v_mul_f32 v25, s42, v25
    v_cvt_pk_bf16_f32 v25, v24, v25
    v_lshlrev_b32 v24, 16, v25
    v_and_b32 v25, 0xffff0000, v25
    s_waitcnt lgkmcnt(0)
    v_lshlrev_b32 v26, 16, v27
    v_and_b32 v27, 0xffff0000, v27
    v_mul_f32 v26, s43, v26
    v_mul_f32 v27, s43, v27
    v_cvt_pk_bf16_f32 v27, v26, v27
    v_lshlrev_b32 v26, 16, v27
    v_and_b32 v27, 0xffff0000, v27
    s_setprio 2
    s_barrier
    buffer_load_dwordx2 v[10:11], v3, s[4:7], 0 offen offset:896
    s_waitcnt vmcnt(2)
    s_add_u32 s3, s47, 61000
    s_mov_b32 m0, s3
    v_mov_b32_dpp v14, v12 wave_ror:1 row_mask:0xf bank_mask:0xf
    v_mov_b32_dpp v15, v13 wave_ror:1 row_mask:0xf bank_mask:0xf
    v_mov_b32_dpp v12, v6 wave_shr:1 row_mask:0xf bank_mask:0xf
    v_mov_b32_dpp v13, v7 wave_shr:1 row_mask:0xf bank_mask:0xf
    v_perm_b32 v248, v6, v4, s44
    v_perm_b32 v249, v4, v12, s44
    v_perm_b32 v250, v6, v4, s45
    v_perm_b32 v251, v4, v12, s45
    v_perm_b32 v252, v7, v5, s44
    v_perm_b32 v253, v5, v13, s44
    v_perm_b32 v254, v7, v5, s45
    v_perm_b32 v255, v5, v13, s45
    ds_write_addtid_b32 v248 offset:3032
    ds_write_addtid_b32 v248 offset:11348
    ds_write_addtid_b32 v249 offset:15504
    ds_write_addtid_b32 v249 offset:7188
    ds_write_addtid_b32 v250 offset:19672
    ds_write_addtid_b32 v250 offset:27988
    ds_write_addtid_b32 v251 offset:32144
    ds_write_addtid_b32 v251 offset:23828
    ds_write_addtid_b32 v252 offset:36312
    ds_write_addtid_b32 v252 offset:44628
    ds_write_addtid_b32 v253 offset:48784
    ds_write_addtid_b32 v253 offset:40468
    ds_write_addtid_b32 v254 offset:52952
    ds_write_addtid_b32 v254 offset:61268
    ds_write_addtid_b32 v255 offset:65424
    ds_write_addtid_b32 v255 offset:57108
    s_mov_b32 m0, s46
    s_waitcnt lgkmcnt(0)
    s_barrier
    ds_read_b64 v[44:45], v18 offset:0
    ds_read_b64 v[52:53], v18 offset:512
    ds_read_b64 v[46:47], v18 offset:256
    ds_read_b64 v[54:55], v18 offset:768
    ds_read_b64 v[48:49], v18 offset:1024
    ds_read_b64 v[56:57], v18 offset:1536
    ds_read_b64 v[50:51], v18 offset:1280
    ds_read_b64 v[58:59], v18 offset:1792
    s_mov_b32 s55, 0
    s_waitcnt lgkmcnt(6)
    v_add_f32 v44, v44, v52
    v_add_f32 v45, v45, v53
    v_cvt_pk_bf16_f32 v45, v44, v45
    v_lshlrev_b32 v44, 16, v45
    v_and_b32 v45, 0xffff0000, v45
    v_add_f32 v44, v44, v20
    v_add_f32 v45, v45, v21
    s_waitcnt lgkmcnt(4)
    v_add_f32 v46, v46, v54
    v_add_f32 v47, v47, v55
    v_cvt_pk_bf16_f32 v47, v46, v47
    v_lshlrev_b32 v46, 16, v47
    v_and_b32 v47, 0xffff0000, v47
    v_add_f32 v46, v46, v22
    v_add_f32 v47, v47, v23
    s_waitcnt lgkmcnt(2)
    v_add_f32 v48, v48, v56
    v_add_f32 v49, v49, v57
    v_cvt_pk_bf16_f32 v49, v48, v49
    v_lshlrev_b32 v48, 16, v49
    v_and_b32 v49, 0xffff0000, v49
    v_add_f32 v48, v48, v24
    v_add_f32 v49, v49, v25
    s_waitcnt lgkmcnt(0)
    v_add_f32 v50, v50, v58
    v_add_f32 v51, v51, v59
    v_cvt_pk_bf16_f32 v51, v50, v51
    v_lshlrev_b32 v50, 16, v51
    v_and_b32 v51, 0xffff0000, v51
    v_add_f32 v50, v50, v26
    v_add_f32 v51, v51, v27
    v_cvt_pk_bf16_f32 v52, v44, v46
    v_cvt_pk_bf16_f32 v53, v48, v50
    buffer_store_dwordx2 v[52:53], v0, s[8:11], s55 offen offset:0
    v_cvt_pk_bf16_f32 v54, v45, v47
    v_cvt_pk_bf16_f32 v55, v49, v51
    v_mfma_f32_16x16x32_bf16 v[40:43], v[240:243], v[64:67], 0
    ds_read_b64 v[92:93], v16 offset:2048
    v_mfma_f32_16x16x32_bf16 v[40:43], v[244:247], v[72:75], v[40:43]
    ds_read_b64 v[94:95], v16 offset:2056
    v_mfma_f32_16x16x32_bf16 v[40:43], v[76:79], v[80:83], v[40:43]
    ds_read_b64 v[64:65], v16 offset:2112
    v_mfma_f32_16x16x32_bf16 v[40:43], v[84:87], v[88:91], v[40:43]
    ds_read_b64 v[66:67], v16 offset:2120
    v_mfma_f32_16x16x32_bf16 v[40:43], v[160:163], v[112:115], v[40:43]
    ds_read_b64 v[240:241], v16 offset:2176
    v_mfma_f32_16x16x32_bf16 v[40:43], v[164:167], v[120:123], v[40:43]
    ds_read_b64 v[242:243], v16 offset:2184
    v_mfma_f32_16x16x32_bf16 v[40:43], v[168:171], v[128:131], v[40:43]
    ds_read_b64 v[72:73], v16 offset:2240
    v_mfma_f32_16x16x32_bf16 v[40:43], v[172:175], v[136:139], v[40:43]
    ds_read_b64 v[74:75], v16 offset:2248
    s_waitcnt vmcnt(1)
    s_add_u32 s3, s47, 62024
    s_mov_b32 m0, s3
    v_mov_b32_dpp v14, v10 wave_shr:1 row_mask:0xf bank_mask:0xf
    v_mov_b32_dpp v15, v11 wave_shr:1 row_mask:0xf bank_mask:0xf
    v_perm_b32 v248, v10, v8, s44
    v_perm_b32 v249, v8, v14, s44
    v_perm_b32 v250, v10, v8, s45
    v_perm_b32 v251, v8, v14, s45
    v_perm_b32 v252, v11, v9, s44
    v_perm_b32 v253, v9, v15, s44
    v_perm_b32 v254, v11, v9, s45
    v_perm_b32 v255, v9, v15, s45
    ds_write_addtid_b32 v248 offset:3032
    ds_write_addtid_b32 v248 offset:11348
    ds_write_addtid_b32 v249 offset:15504
    ds_write_addtid_b32 v249 offset:7188
    ds_write_addtid_b32 v250 offset:19672
    ds_write_addtid_b32 v250 offset:27988
    ds_write_addtid_b32 v251 offset:32144
    ds_write_addtid_b32 v251 offset:23828
    ds_write_addtid_b32 v252 offset:36312
    ds_write_addtid_b32 v252 offset:44628
    ds_write_addtid_b32 v253 offset:48784
    ds_write_addtid_b32 v253 offset:40468
    ds_write_addtid_b32 v254 offset:52952
    ds_write_addtid_b32 v254 offset:61268
    ds_write_addtid_b32 v255 offset:65424
    ds_write_addtid_b32 v255 offset:57108
    s_mov_b32 m0, s46
    s_waitcnt lgkmcnt(0)
    s_barrier
    ds_read_b64 v[244:245], v16 offset:2560
    ds_read_b64 v[246:247], v16 offset:2568
    v_mfma_f32_16x16x32_bf16 v[40:43], v[176:179], v[144:147], v[40:43]
    ds_read_b64 v[80:81], v16 offset:2624
    v_mfma_f32_16x16x32_bf16 v[40:43], v[180:183], v[148:151], v[40:43]
    ds_read_b64 v[82:83], v16 offset:2632
    v_mfma_f32_16x16x32_bf16 v[40:43], v[184:187], v[152:155], v[40:43]
    ds_read_b64 v[76:77], v16 offset:2688
    v_mfma_f32_16x16x32_bf16 v[40:43], v[188:191], v[156:159], v[40:43]
    ds_read_b64 v[78:79], v16 offset:2696
    v_mfma_f32_16x16x32_bf16 v[40:43], v[192:195], v[208:211], v[40:43]
    ds_read_b64 v[88:89], v16 offset:2752
    v_mfma_f32_16x16x32_bf16 v[40:43], v[196:199], v[216:219], v[40:43]
    ds_read_b64 v[90:91], v16 offset:2760
    v_mfma_f32_16x16x32_bf16 v[40:43], v[200:203], v[224:227], v[40:43]
    ds_read_b64 v[84:85], v16 offset:3072
    v_mfma_f32_16x16x32_bf16 v[40:43], v[204:207], v[232:235], v[40:43]
    ds_read_b64 v[86:87], v16 offset:3080
    v_mfma_f32_16x16x32_bf16 v[36:39], v[96:99], v[92:95], v[36:39]
    ds_read_b64 v[112:113], v16 offset:3136
    v_mfma_f32_16x16x32_bf16 v[36:39], v[100:103], v[64:67], v[36:39]
    ds_read_b64 v[114:115], v16 offset:3144
    v_mfma_f32_16x16x32_bf16 v[36:39], v[104:107], v[240:243], v[36:39]
    ds_read_b128 v[160:163], v17 offset:3648
    v_mfma_f32_16x16x32_bf16 v[36:39], v[108:111], v[72:75], v[36:39]
    ds_read_b64 v[120:121], v16 offset:3200
    s_waitcnt lgkmcnt(12)
    v_mfma_f32_16x16x32_bf16 v[36:39], v[116:119], v[244:247], v[36:39]
    ds_read_b64 v[122:123], v16 offset:3208
    s_waitcnt lgkmcnt(11)
    v_mfma_f32_16x16x32_bf16 v[36:39], v[124:127], v[80:83], v[36:39]
    ds_read_b128 v[164:167], v17 offset:3712
    s_waitcnt lgkmcnt(10)
    v_mfma_f32_16x16x32_bf16 v[36:39], v[132:135], v[76:79], v[36:39]
    ds_read_b64 v[128:129], v16 offset:3264
    s_waitcnt lgkmcnt(9)
    v_mfma_f32_16x16x32_bf16 v[36:39], v[140:143], v[88:91], v[36:39]
    ds_read_b64 v[130:131], v16 offset:3272
    v_mfma_f32_16x16x32_bf16 v[40:43], v[212:215], v[92:95], v[40:43]
    ds_read_b128 v[168:171], v17 offset:3776
    v_mfma_f32_16x16x32_bf16 v[40:43], v[220:223], v[64:67], v[40:43]
    ds_read_b64 v[136:137], v16 offset:3584
    v_mfma_f32_16x16x32_bf16 v[40:43], v[228:231], v[240:243], v[40:43]
    ds_read_b64 v[138:139], v16 offset:3592
    v_mfma_f32_16x16x32_bf16 v[40:43], v[236:239], v[72:75], v[40:43]
    ds_read_b64 v[172:173], v16 offset:3648
    v_mfma_f32_16x16x32_bf16 v[40:43], v[96:99], v[244:247], v[40:43]
    ds_read_b64 v[174:175], v16 offset:3656
    v_mfma_f32_16x16x32_bf16 v[40:43], v[100:103], v[80:83], v[40:43]
    ds_read_b64 v[144:145], v16 offset:3712
    v_mfma_f32_16x16x32_bf16 v[40:43], v[104:107], v[76:79], v[40:43]
    ds_read_b64 v[146:147], v16 offset:3720
    v_mfma_f32_16x16x32_bf16 v[40:43], v[108:111], v[88:91], v[40:43]
    ds_read_b64 v[176:177], v16 offset:3776
    s_waitcnt lgkmcnt(15)
    v_mfma_f32_16x16x32_bf16 v[36:39], v[68:71], v[84:87], v[36:39]
    ds_read_b64 v[178:179], v16 offset:3784
    s_waitcnt lgkmcnt(14)
    v_mfma_f32_16x16x32_bf16 v[36:39], v[160:163], v[112:115], v[36:39]
    s_waitcnt lgkmcnt(11)
    v_mfma_f32_16x16x32_bf16 v[36:39], v[164:167], v[120:123], v[36:39]
    s_waitcnt lgkmcnt(8)
    v_mfma_f32_16x16x32_bf16 v[36:39], v[168:171], v[128:131], v[36:39]
    s_nop 7
    ds_write_addtid_b32 v36 offset:4128
    ds_write_addtid_b32 v37 offset:12384
    ds_write_addtid_b32 v38 offset:20640
    ds_write_addtid_b32 v39 offset:28896
    buffer_store_dwordx2 v[54:55], v0, s[8:11], s55 offen offset:896
    ds_read_b32 v21, v19 offset:3072
    ds_read_b32 v23, v19 offset:19712
    ds_read_b32 v25, v19 offset:36352
    ds_read_b32 v27, v19 offset:52992
    s_waitcnt lgkmcnt(3)
    v_lshlrev_b32 v20, 16, v21
    v_and_b32 v21, 0xffff0000, v21
    v_mul_f32 v20, s40, v20
    v_mul_f32 v21, s40, v21
    v_cvt_pk_bf16_f32 v21, v20, v21
    v_lshlrev_b32 v20, 16, v21
    v_and_b32 v21, 0xffff0000, v21
    s_waitcnt lgkmcnt(2)
    v_lshlrev_b32 v22, 16, v23
    v_and_b32 v23, 0xffff0000, v23
    v_mul_f32 v22, s41, v22
    v_mul_f32 v23, s41, v23
    v_cvt_pk_bf16_f32 v23, v22, v23
    v_lshlrev_b32 v22, 16, v23
    v_and_b32 v23, 0xffff0000, v23
    s_waitcnt lgkmcnt(1)
    v_lshlrev_b32 v24, 16, v25
    v_and_b32 v25, 0xffff0000, v25
    v_mul_f32 v24, s42, v24
    v_mul_f32 v25, s42, v25
    v_cvt_pk_bf16_f32 v25, v24, v25
    v_lshlrev_b32 v24, 16, v25
    v_and_b32 v25, 0xffff0000, v25
    s_waitcnt lgkmcnt(0)
    v_lshlrev_b32 v26, 16, v27
    v_and_b32 v27, 0xffff0000, v27
    v_mul_f32 v26, s43, v26
    v_mul_f32 v27, s43, v27
    v_cvt_pk_bf16_f32 v27, v26, v27
    v_lshlrev_b32 v26, 16, v27
    v_and_b32 v27, 0xffff0000, v27
    s_barrier
    ds_read_b64 v[44:45], v18 offset:4128
    ds_read_b64 v[52:53], v18 offset:4640
    ds_read_b64 v[46:47], v18 offset:4384
    ds_read_b64 v[54:55], v18 offset:4896
    ds_read_b64 v[48:49], v18 offset:5152
    ds_read_b64 v[56:57], v18 offset:5664
    ds_read_b64 v[50:51], v18 offset:5408
    ds_read_b64 v[58:59], v18 offset:5920
    s_mov_b32 s55, 1376256
    s_waitcnt lgkmcnt(6)
    v_add_f32 v44, v44, v52
    v_add_f32 v45, v45, v53
    v_cvt_pk_bf16_f32 v45, v44, v45
    v_lshlrev_b32 v44, 16, v45
    v_and_b32 v45, 0xffff0000, v45
    v_add_f32 v44, v44, v20
    v_add_f32 v45, v45, v21
    s_waitcnt lgkmcnt(4)
    v_add_f32 v46, v46, v54
    v_add_f32 v47, v47, v55
    v_cvt_pk_bf16_f32 v47, v46, v47
    v_lshlrev_b32 v46, 16, v47
    v_and_b32 v47, 0xffff0000, v47
    v_add_f32 v46, v46, v22
    v_add_f32 v47, v47, v23
    s_waitcnt lgkmcnt(2)
    v_add_f32 v48, v48, v56
    v_add_f32 v49, v49, v57
    v_cvt_pk_bf16_f32 v49, v48, v49
    v_lshlrev_b32 v48, 16, v49
    v_and_b32 v49, 0xffff0000, v49
    v_add_f32 v48, v48, v24
    v_add_f32 v49, v49, v25
    s_waitcnt lgkmcnt(0)
    v_add_f32 v50, v50, v58
    v_add_f32 v51, v51, v59
    v_cvt_pk_bf16_f32 v51, v50, v51
    v_lshlrev_b32 v50, 16, v51
    v_and_b32 v51, 0xffff0000, v51
    v_add_f32 v50, v50, v26
    v_add_f32 v51, v51, v27
    v_cvt_pk_bf16_f32 v52, v44, v46
    v_cvt_pk_bf16_f32 v53, v48, v50
    buffer_store_dwordx2 v[52:53], v0, s[8:11], s55 offen offset:0
    v_cvt_pk_bf16_f32 v54, v45, v47
    v_cvt_pk_bf16_f32 v55, v49, v51
    buffer_store_dwordx2 v[54:55], v0, s[8:11], s55 offen offset:896
    v_mfma_f32_16x16x32_bf16 v[40:43], v[116:119], v[84:87], v[40:43]
    v_mfma_f32_16x16x32_bf16 v[40:43], v[124:127], v[112:115], v[40:43]
    v_mfma_f32_16x16x32_bf16 v[40:43], v[132:135], v[120:123], v[40:43]
    v_mfma_f32_16x16x32_bf16 v[40:43], v[140:143], v[128:131], v[40:43]
    v_mfma_f32_16x16x32_bf16 v[40:43], v[68:71], v[136:139], v[40:43]
    v_mfma_f32_16x16x32_bf16 v[40:43], v[160:163], v[172:175], v[40:43]
    v_mfma_f32_16x16x32_bf16 v[40:43], v[164:167], v[144:147], v[40:43]
    v_mfma_f32_16x16x32_bf16 v[40:43], v[168:171], v[176:179], v[40:43]
    s_nop 7
    ds_write_addtid_b32 v40 offset:6192
    ds_write_addtid_b32 v41 offset:14448
    ds_write_addtid_b32 v42 offset:22704
    ds_write_addtid_b32 v43 offset:30960
    s_waitcnt lgkmcnt(0)
    s_barrier
    s_endpgm
.p2align 6
L_t1:
    s_branch L_tback
    s_nop 0
L_cv1:
    s_setprio 0
    s_mul_i32 s48, s33, 4608
    s_add_u32 s48, s48, 130560
    v_and_b32 v46, 31, v1
    v_lshrrev_b32 v47, 5, v1
    v_lshlrev_b32 v250, 4, v46
    s_waitcnt lgkmcnt(7)
    v_mfma_f32_32x32x16_f16 v[224:239], v[192:195], v[128:131], 0
    v_lshl_add_u32 v250, v47, 3, v250
    s_add_u32 s3, s48, 4088
    v_sub_u32 v250, s3, v250
    v_lshlrev_b32 v251, 4, v1
    s_xor_b32 s3, s15, s34
    s_waitcnt lgkmcnt(6)
    v_mfma_f32_32x32x16_f16 v[224:239], v[196:199], v[132:135], v[224:239]
    s_lshl_b32 s3, s3, 2
    s_and_b32 s57, s32, 3
    s_add_u32 s3, s3, s57
    s_lshl_b32 s3, s3, 11
    s_add_u32 s3, s3, s96
    s_waitcnt lgkmcnt(5)
    v_mfma_f32_32x32x16_f16 v[224:239], v[200:203], v[136:139], v[224:239]
    s_sub_u32 s3, s3, 32768
    v_add_u32 v249, s3, v251
    s_add_u32 s3, s48, 1008
    v_sub_u32 v251, s3, v251
    v_and_b32 v46, 15, v1
    s_waitcnt lgkmcnt(4)
    v_mfma_f32_32x32x16_f16 v[224:239], v[204:207], v[140:143], v[224:239]
    v_and_b32 v47, 48, v1
    v_add_u32 v48, 1, v46
    v_and_b32 v49, 3, v48
    v_and_b32 v48, 28, v48
    v_mul_u32_u24 v49, 4160, v49
    s_waitcnt lgkmcnt(3)
    v_mfma_f32_32x32x16_f16 v[224:239], v[208:211], v[144:147], v[224:239]
    v_lshl_add_u32 v48, v48, 1, v47
    s_and_b32 s57, s32, 2
    s_lshl_b32 s57, s57, 7
    s_mul_i32 s3, s33, 16640
    s_add_u32 s3, s3, s57
    s_waitcnt lgkmcnt(2)
    v_mfma_f32_32x32x16_f16 v[224:239], v[212:215], v[148:151], v[224:239]
    s_add_u32 s3, s3, 64000
    v_add3_u32 v16, v48, v49, s3
    s_add_u32 s3, s48, s57
    s_add_u32 s3, s3, 480
    v_lshlrev_b32 v48, 5, v46
    s_waitcnt lgkmcnt(1)
    v_mfma_f32_32x32x16_f16 v[224:239], v[216:219], v[152:155], v[224:239]
    v_add_u32 v49, s3, v47
    v_sub_u32 v17, v49, v48
    s_mov_b32 s44, 0x05040100
    s_mov_b32 s45, 0x07060302
    s_waitcnt lgkmcnt(0)
    v_mfma_f32_32x32x16_f16 v[224:239], v[220:223], v[156:159], v[224:239]
    s_waitcnt vmcnt(1)
    v_readfirstlane_b32 s3, v248
    s_nop 1
    s_mul_i32 s3, s3, 0x9e3779b1
    s_add_u32 s3, s3, 0x7f4a7c15
    s_getreg_b32 s97, hwreg(HW_REG_XCC_ID)
    s_and_b32 s97, s97, 7
    s_add_u32 s97, s97, 1
    s_xor_b32 s97, s97, s3
    s_mov_b32 s99, s3
    v_mov_b32 v60, s97
    v_mul_f32 v224, v224, v43
    ds_write_addtid_b32 v224 offset:0
    v_mul_f32 v225, v225, v43
    ds_write_addtid_b32 v225 offset:2064
    v_mul_f32 v226, v226, v43
    ds_write_addtid_b32 v226 offset:4128
    v_mul_f32 v227, v227, v43
    ds_write_addtid_b32 v227 offset:6192
    v_mul_f32 v228, v228, v43
    ds_write_addtid_b32 v228 offset:8256
    v_mul_f32 v229, v229, v43
    ds_write_addtid_b32 v229 offset:10320
    v_mul_f32 v230, v230, v43
    ds_write_addtid_b32 v230 offset:12384
    v_mul_f32 v231, v231, v43
    ds_write_addtid_b32 v231 offset:14448
    s_mov_b32 m0, s53
    s_waitcnt lgkmcnt(0)
    s_setprio 2
    s_barrier
    ds_read_addtid_b32 v160 offset:16512
    ds_read_addtid_b32 v161 offset:18576
    ds_read_addtid_b32 v162 offset:20640
    ds_read_addtid_b32 v163 offset:22704
    ds_read_addtid_b32 v164 offset:24768
    ds_read_addtid_b32 v168 offset:17536
    ds_read_addtid_b32 v169 offset:19600
    ds_read_addtid_b32 v170 offset:21664
    ds_read_addtid_b32 v171 offset:23728
    ds_read_addtid_b32 v172 offset:25792
    ds_read_addtid_b32 v176 offset:18048
    ds_read_addtid_b32 v177 offset:20112
    ds_read_addtid_b32 v178 offset:22176
    ds_read_addtid_b32 v179 offset:24240
    ds_read_addtid_b32 v180 offset:26304
    s_mov_b32 m0, s46
    v_mov_b32 v187, v60
    v_mov_b32 v189, v60
    s_waitcnt lgkmcnt(10)
    v_fma_f32 v232, v232, v43, v160
    v_fma_f32 v233, v233, v43, v161
    v_fma_f32 v234, v234, v43, v162
    v_fma_f32 v235, v235, v43, v163
    v_fma_f32 v236, v236, v43, v164
    s_waitcnt lgkmcnt(5)
    v_add_f32 v232, v232, v168
    v_add_f32 v233, v233, v169
    v_add_f32 v234, v234, v170
    v_add_f32 v235, v235, v171
    v_add_f32 v236, v236, v172
    s_waitcnt lgkmcnt(0)
    v_add_f32 v232, v232, v176
    v_add_f32 v233, v233, v177
    v_add_f32 v234, v234, v178
    v_add_f32 v235, v235, v179
    v_add_f32 v236, v236, v180
    v_cvt_pk_bf16_f32 v184, v232, v233
    v_cvt_pk_bf16_f32 v185, v234, v235
    v_cvt_pk_bf16_f32 v186, v236, v236
    global_store_dwordx4 v249, v[184:187], s[62:63]
    s_mov_b32 vcc_lo, 0xaaaaaaaa
    s_mov_b32 vcc_hi, 0xaaaaaaaa
    v_mov_b32_dpp v240, v234 wave_rol:1 row_mask:0xf bank_mask:0xf
    v_cvt_pk_bf16_f32 v225, v233, v233
    v_cvt_pk_bf16_f32 v226, v233, v232
    v_mov_b32_dpp v240, v232 wave_shl:1 row_mask:0xf bank_mask:0xf
    v_cvt_pk_bf16_f32 v227, v232, v232
    v_mov_b32_dpp v241, v235 wave_rol:1 row_mask:0xf bank_mask:0xf
    v_cvt_pk_bf16_f32 v224, v240, v240
    v_mov_b32_dpp v242, v236 wave_rol:1 row_mask:0xf bank_mask:0xf
    ds_write_b128 v251, v[224:227] offset:2048
    v_mov_b32_dpp v241, v234 wave_shl:1 row_mask:0xf bank_mask:0xf
    v_mov_b32_dpp v242, v235 wave_shl:1 row_mask:0xf bank_mask:0xf
    v_cndmask_b32 v243, v234, v241, vcc
    v_cvt_pk_bf16_f32 v230, v234, v234
    v_cvt_pk_bf16_f32 v231, v234, v234
    v_cvt_pk_bf16_f32 v228, v241, v241
    v_cvt_pk_bf16_f32 v229, v241, v243
    ds_write_b128 v251, v[228:231] offset:1024
    v_cndmask_b32 v243, v235, v242, vcc
    v_cvt_pk_bf16_f32 v246, v235, v235
    v_cvt_pk_bf16_f32 v247, v235, v235
    v_cvt_pk_bf16_f32 v244, v242, v242
    v_cvt_pk_bf16_f32 v245, v242, v243
    ds_write_b128 v251, v[244:247] offset:0
    s_waitcnt lgkmcnt(0)
    s_setprio 0
    s_barrier
    ds_read_b64 v[64:65], v16 offset:0
    ds_read_b64 v[66:67], v16 offset:8
    ds_read_b128 v[68:71], v17 offset:3584
    ds_read_b64 v[72:73], v16 offset:64
    ds_read_b64 v[74:75], v16 offset:72
    ds_read_b128 v[76:79], v17 offset:3648
    ds_read_b64 v[80:81], v16 offset:128
    ds_read_b64 v[82:83], v16 offset:136
    ds_read_b128 v[84:87], v17 offset:3712
    ds_read_b64 v[88:89], v16 offset:192
    ds_read_b64 v[90:91], v16 offset:200
    ds_read_b128 v[92:95], v17 offset:3776
    ds_read_b128 v[96:99], v17 offset:2560
    ds_read_b128 v[100:103], v17 offset:2624
    ds_read_b128 v[104:107], v17 offset:2688
    ds_read_b128 v[108:111], v17 offset:2752
    s_waitcnt lgkmcnt(13)
    v_mfma_f32_16x16x32_bf16 v[28:31], v[68:71], v[64:67], 0
    ds_read_b64 v[112:113], v16 offset:512
    s_waitcnt lgkmcnt(11)
    v_mfma_f32_16x16x32_bf16 v[28:31], v[76:79], v[72:75], v[28:31]
    ds_read_b64 v[114:115], v16 offset:520
    ds_read_b128 v[116:119], v17 offset:3072
    s_waitcnt lgkmcnt(10)
    v_mfma_f32_16x16x32_bf16 v[28:31], v[84:87], v[80:83], v[28:31]
    ds_read_b64 v[120:121], v16 offset:576
    ds_read_b64 v[122:123], v16 offset:584
    ds_read_b128 v[124:127], v17 offset:3136
    buffer_load_dwordx2 v[4:5], v2, s[4:7], 0 offen offset:0
    s_waitcnt lgkmcnt(10)
    v_mfma_f32_16x16x32_bf16 v[28:31], v[92:95], v[88:91], v[28:31]
    ds_read_b64 v[128:129], v16 offset:640
    ds_read_b64 v[130:131], v16 offset:648
    ds_read_b128 v[132:135], v17 offset:3200
    s_waitcnt lgkmcnt(12)
    v_mfma_f32_16x16x32_bf16 v[32:35], v[96:99], v[64:67], 0
    ds_read_b64 v[136:137], v16 offset:704
    ds_read_b64 v[138:139], v16 offset:712
    ds_read_b128 v[140:143], v17 offset:3264
    s_waitcnt lgkmcnt(14)
    v_mfma_f32_16x16x32_bf16 v[32:35], v[100:103], v[72:75], v[32:35]
    ds_read_b64 v[144:145], v16 offset:1024
    ds_read_b64 v[146:147], v16 offset:1032
    s_waitcnt lgkmcnt(15)
    v_mfma_f32_16x16x32_bf16 v[32:35], v[104:107], v[80:83], v[32:35]
    ds_read_b64 v[148:149], v16 offset:1088
    ds_read_b64 v[150:151], v16 offset:1096
    ds_write_addtid_b32 v28 offset:0
    s_waitcnt lgkmcnt(15)
    v_mfma_f32_16x16x32_bf16 v[32:35], v[108:111], v[88:91], v[32:35]
    ds_read_b64 v[152:153], v16 offset:1152
    ds_read_b64 v[154:155], v16 offset:1160
    ds_write_addtid_b32 v29 offset:8256
    s_waitcnt lgkmcnt(15)
    v_mfma_f32_16x16x32_bf16 v[32:35], v[116:119], v[112:115], v[32:35]
    ds_read_b64 v[156:157], v16 offset:1216
    ds_read_b64 v[158:159], v16 offset:1224
    ds_write_addtid_b32 v30 offset:16512
    s_waitcnt lgkmcnt(15)
    v_mfma_f32_16x16x32_bf16 v[32:35], v[124:127], v[120:123], v[32:35]
    ds_read_b128 v[160:163], v17 offset:512
    ds_write_addtid_b32 v31 offset:24768
    s_waitcnt lgkmcnt(15)
    v_mfma_f32_16x16x32_bf16 v[32:35], v[132:135], v[128:131], v[32:35]
    ds_read_b128 v[164:167], v17 offset:576
    s_waitcnt lgkmcnt(14)
    v_mfma_f32_16x16x32_bf16 v[32:35], v[140:143], v[136:139], v[32:35]
    ds_read_b128 v[168:171], v17 offset:640
    buffer_load_dwordx2 v[6:7], v2, s[4:7], 0 offen offset:896
    s_waitcnt lgkmcnt(13)
    v_mfma_f32_16x16x32_bf16 v[32:35], v[68:71], v[144:147], v[32:35]
    ds_read_b128 v[172:175], v17 offset:704
    s_waitcnt lgkmcnt(12)
    v_mfma_f32_16x16x32_bf16 v[32:35], v[76:79], v[148:151], v[32:35]
    ds_read_b128 v[176:179], v17 offset:1024
    s_waitcnt lgkmcnt(10)
    v_mfma_f32_16x16x32_bf16 v[32:35], v[84:87], v[152:155], v[32:35]
    ds_read_b128 v[180:183], v17 offset:1088
    s_waitcnt lgkmcnt(8)
    v_mfma_f32_16x16x32_bf16 v[32:35], v[92:95], v[156:159], v[32:35]
    ds_read_b128 v[184:187], v17 offset:1152
    s_waitcnt lgkmcnt(7)
    v_mfma_f32_16x16x32_bf16 v[36:39], v[160:163], v[64:67], 0
    ds_read_b128 v[188:191], v17 offset:1216
    s_waitcnt lgkmcnt(6)
    v_mfma_f32_16x16x32_bf16 v[36:39], v[164:167], v[72:75], v[36:39]
    ds_read_b128 v[192:195], v17 offset:1536
    s_waitcnt lgkmcnt(6)
    v_mfma_f32_16x16x32_bf16 v[36:39], v[168:171], v[80:83], v[36:39]
    ds_read_b128 v[196:199], v17 offset:1600
    ds_write_addtid_b32 v32 offset:2064
    s_waitcnt lgkmcnt(7)
    v_mfma_f32_16x16x32_bf16 v[36:39], v[172:175], v[88:91], v[36:39]
    ds_read_b128 v[200:203], v17 offset:1664
    ds_write_addtid_b32 v33 offset:10320
    s_waitcnt lgkmcnt(8)
    v_mfma_f32_16x16x32_bf16 v[36:39], v[176:179], v[112:115], v[36:39]
    ds_read_b128 v[204:207], v17 offset:1728
    ds_write_addtid_b32 v34 offset:18576
    s_waitcnt lgkmcnt(9)
    v_mfma_f32_16x16x32_bf16 v[36:39], v[180:183], v[120:123], v[36:39]
    ds_read_b64 v[208:209], v16 offset:1536
    ds_read_b64 v[210:211], v16 offset:1544
    ds_read_b128 v[212:215], v17 offset:2048
    ds_write_addtid_b32 v35 offset:26832
    s_waitcnt lgkmcnt(12)
    v_mfma_f32_16x16x32_bf16 v[36:39], v[184:187], v[128:131], v[36:39]
    ds_read_b64 v[216:217], v16 offset:1600
    ds_read_b64 v[218:219], v16 offset:1608
    ds_read_b128 v[220:223], v17 offset:2112
    s_waitcnt lgkmcnt(14)
    v_mfma_f32_16x16x32_bf16 v[36:39], v[188:191], v[136:139], v[36:39]
    ds_read_b64 v[224:225], v16 offset:1664
    ds_read_b64 v[226:227], v16 offset:1672
    ds_read_b128 v[228:231], v17 offset:2176
    s_waitcnt lgkmcnt(15)
    v_mfma_f32_16x16x32_bf16 v[36:39], v[192:195], v[144:147], v[36:39]
    ds_read_b64 v[232:233], v16 offset:1728
    ds_read_b64 v[234:235], v16 offset:1736
    ds_read_b128 v[236:239], v17 offset:2240
    v_mfma_f32_16x16x32_bf16 v[36:39], v[196:199], v[148:151], v[36:39]
    ds_read_b128 v[240:243], v17 offset:0
    s_waitcnt lgkmcnt(15)
    v_mfma_f32_16x16x32_bf16 v[36:39], v[200:203], v[152:155], v[36:39]
    ds_read_b128 v[244:247], v17 offset:64
    v_mfma_f32_16x16x32_bf16 v[36:39], v[204:207], v[156:159], v[36:39]
    ds_read_b128 v[76:79], v17 offset:128
    s_waitcnt lgkmcnt(13)
    v_mfma_f32_16x16x32_bf16 v[36:39], v[212:215], v[208:211], v[36:39]
    ds_read_b128 v[84:87], v17 offset:192
    s_waitcnt lgkmcnt(10)
    v_mfma_f32_16x16x32_bf16 v[36:39], v[220:223], v[216:219], v[36:39]
    s_waitcnt lgkmcnt(7)
    v_mfma_f32_16x16x32_bf16 v[36:39], v[228:231], v[224:227], v[36:39]
    s_waitcnt lgkmcnt(4)
    v_mfma_f32_16x16x32_bf16 v[36:39], v[236:239], v[232:235], v[36:39]
    v_bfe_u32 v46, v1, 3, 2
    v_mul_u32_u24 v46, 8256, v46
    v_and_b32 v47, 32, v1
    v_lshl_add_u32 v46, v47, 1, v46
    v_and_b32 v47, 7, v1
    v_lshl_add_u32 v46, v47, 3, v46
    s_lshr_b32 s3, s53, 1
    v_add_u32 v18, s3, v46
    s_add_u32 s3, s53, 64032
    v_lshl_add_u32 v19, v1, 2, s3
    v_mul_u32_u24 v47, 1792, v1
    s_mul_i32 s3, s53, 448
    s_add_u32 s3, s3, s14
    v_add_u32 v0, s3, v47
    s_mov_b32 s8, s30
    s_mov_b32 s9, s31
    s_mov_b32 s10, 1835008
    s_mov_b32 s11, 0x20000
    s_lshl_b32 s40, s38, 16
    s_and_b32 s41, s38, 0xffff0000
    s_lshl_b32 s42, s39, 16
    s_and_b32 s43, s39, 0xffff0000
    ds_read_b32 v21, v19 offset:1024
    ds_read_b32 v23, v19 offset:17664
    ds_read_b32 v25, v19 offset:34304
    ds_read_b32 v27, v19 offset:50944
    s_waitcnt lgkmcnt(3)
    v_lshlrev_b32 v20, 16, v21
    v_and_b32 v21, 0xffff0000, v21
    v_mul_f32 v20, s40, v20
    v_mul_f32 v21, s40, v21
    v_cvt_pk_bf16_f32 v21, v20, v21
    v_lshlrev_b32 v20, 16, v21
    v_and_b32 v21, 0xffff0000, v21
    s_waitcnt lgkmcnt(2)
    v_lshlrev_b32 v22, 16, v23
    v_and_b32 v23, 0xffff0000, v23
    v_mul_f32 v22, s41, v22
    v_mul_f32 v23, s41, v23
    v_cvt_pk_bf16_f32 v23, v22, v23
    v_lshlrev_b32 v22, 16, v23
    v_and_b32 v23, 0xffff0000, v23
    s_waitcnt lgkmcnt(1)
    v_lshlrev_b32 v24, 16, v25
    v_and_b32 v25, 0xffff0000, v25
    v_mul_f32 v24, s42, v24
    v_mul_f32 v25, s42, v25
    v_cvt_pk_bf16_f32 v25, v24, v25
    v_lshlrev_b32 v24, 16, v25
    v_and_b32 v25, 0xffff0000, v25
    s_waitcnt lgkmcnt(0)
    v_lshlrev_b32 v26, 16, v27
    v_and_b32 v27, 0xffff0000, v27
    v_mul_f32 v26, s43, v26
    v_mul_f32 v27, s43, v27
    v_cvt_pk_bf16_f32 v27, v26, v27
    v_lshlrev_b32 v26, 16, v27
    v_and_b32 v27, 0xffff0000, v27
    s_setprio 2
    s_barrier
    buffer_load_dwordx2 v[8:9], v3, s[4:7], 0 offen offset:0
    buffer_load_dwordx2 v[10:11], v3, s[4:7], 0 offen offset:896
    s_waitcnt vmcnt(2)
    s_add_u32 s3, s47, 61000
    s_mov_b32 m0, s3
    v_mov_b32_dpp v14, v12 wave_ror:1 row_mask:0xf bank_mask:0xf
    v_mov_b32_dpp v15, v13 wave_ror:1 row_mask:0xf bank_mask:0xf
    v_mov_b32_dpp v12, v6 wave_shr:1 row_mask:0xf bank_mask:0xf
    v_mov_b32_dpp v13, v7 wave_shr:1 row_mask:0xf bank_mask:0xf
    v_perm_b32 v248, v6, v4, s44
    v_perm_b32 v249, v4, v12, s44
    v_perm_b32 v250, v6, v4, s45
    v_perm_b32 v251, v4, v12, s45
    v_perm_b32 v252, v7, v5, s44
    v_perm_b32 v253, v5, v13, s44
    v_perm_b32 v254, v7, v5, s45
    v_perm_b32 v255, v5, v13, s45
    ds_write_addtid_b32 v248 offset:3032
    ds_write_addtid_b32 v248 offset:11348
    ds_write_addtid_b32 v249 offset:15504
    ds_write_addtid_b32 v249 offset:7188
    ds_write_addtid_b32 v250 offset:19672
    ds_write_addtid_b32 v250 offset:27988
    ds_write_addtid_b32 v251 offset:32144
    ds_write_addtid_b32 v251 offset:23828
    ds_write_addtid_b32 v252 offset:36312
    ds_write_addtid_b32 v252 offset:44628
    ds_write_addtid_b32 v253 offset:48784
    ds_write_addtid_b32 v253 offset:40468
    ds_write_addtid_b32 v254 offset:52952
    ds_write_addtid_b32 v254 offset:61268
    ds_write_addtid_b32 v255 offset:65424
    ds_write_addtid_b32 v255 offset:57108
    s_mov_b32 m0, s46
    s_waitcnt lgkmcnt(0)
    s_barrier
    v_mfma_f32_16x16x32_bf16 v[40:43], v[240:243], v[64:67], 0
    ds_read_b64 v[92:93], v16 offset:2048
    v_mfma_f32_16x16x32_bf16 v[40:43], v[244:247], v[72:75], v[40:43]
    ds_read_b64 v[94:95], v16 offset:2056
    v_mfma_f32_16x16x32_bf16 v[40:43], v[76:79], v[80:83], v[40:43]
    ds_read_b64 v[64:65], v16 offset:2112
    v_mfma_f32_16x16x32_bf16 v[40:43], v[84:87], v[88:91], v[40:43]
    ds_read_b64 v[66:67], v16 offset:2120
    v_mfma_f32_16x16x32_bf16 v[40:43], v[160:163], v[112:115], v[40:43]
    ds_read_b64 v[240:241], v16 offset:2176
    v_mfma_f32_16x16x32_bf16 v[40:43], v[164:167], v[120:123], v[40:43]
    ds_read_b64 v[242:243], v16 offset:2184
    v_mfma_f32_16x16x32_bf16 v[40:43], v[168:171], v[128:131], v[40:43]
    ds_read_b64 v[72:73], v16 offset:2240
    v_mfma_f32_16x16x32_bf16 v[40:43], v[172:175], v[136:139], v[40:43]
    ds_read_b64 v[74:75], v16 offset:2248
    s_waitcnt vmcnt(0)
    s_add_u32 s3, s47, 62024
    s_mov_b32 m0, s3
    v_mov_b32_dpp v14, v10 wave_shr:1 row_mask:0xf bank_mask:0xf
    v_mov_b32_dpp v15, v11 wave_shr:1 row_mask:0xf bank_mask:0xf
    v_perm_b32 v248, v10, v8, s44
    v_perm_b32 v249, v8, v14, s44
    v_perm_b32 v250, v10, v8, s45
    v_perm_b32 v251, v8, v14, s45
    v_perm_b32 v252, v11, v9, s44
    v_perm_b32 v253, v9, v15, s44
    v_perm_b32 v254, v11, v9, s45
    v_perm_b32 v255, v9, v15, s45
    ds_write_addtid_b32 v248 offset:3032
    ds_write_addtid_b32 v248 offset:11348
    ds_write_addtid_b32 v249 offset:15504
    ds_write_addtid_b32 v249 offset:7188
    ds_write_addtid_b32 v250 offset:19672
    ds_write_addtid_b32 v250 offset:27988
    ds_write_addtid_b32 v251 offset:32144
    ds_write_addtid_b32 v251 offset:23828
    ds_write_addtid_b32 v252 offset:36312
    ds_write_addtid_b32 v252 offset:44628
    ds_write_addtid_b32 v253 offset:48784
    ds_write_addtid_b32 v253 offset:40468
    ds_write_addtid_b32 v254 offset:52952
    ds_write_addtid_b32 v254 offset:61268
    ds_write_addtid_b32 v255 offset:65424
    ds_write_addtid_b32 v255 offset:57108
    s_mov_b32 m0, s46
    s_waitcnt lgkmcnt(0)
    s_barrier
    ds_read_b64 v[44:45], v18 offset:2064
    ds_read_b64 v[52:53], v18 offset:2576
    ds_read_b64 v[46:47], v18 offset:2320
    ds_read_b64 v[54:55], v18 offset:2832
    ds_read_b64 v[48:49], v18 offset:3088
    ds_read_b64 v[56:57], v18 offset:3600
    ds_read_b64 v[50:51], v18 offset:3344
    ds_read_b64 v[58:59], v18 offset:3856
    ds_read_b64 v[244:245], v16 offset:2560
    ds_read_b64 v[246:247], v16 offset:2568
    s_mov_b32 s55, 458752
    s_waitcnt lgkmcnt(8)
    v_add_f32 v44, v44, v52
    v_add_f32 v45, v45, v53
    v_cvt_pk_bf16_f32 v45, v44, v45
    v_lshlrev_b32 v44, 16, v45
    v_and_b32 v45, 0xffff0000, v45
    v_add_f32 v44, v44, v20
    v_add_f32 v45, v45, v21
    s_waitcnt lgkmcnt(6)
    v_add_f32 v46, v46, v54
    v_add_f32 v47, v47, v55
    v_cvt_pk_bf16_f32 v47, v46, v47
    v_lshlrev_b32 v46, 16, v47
    v_and_b32 v47, 0xffff0000, v47
    v_add_f32 v46, v46, v22
    v_add_f32 v47, v47, v23
    s_waitcnt lgkmcnt(4)
    v_add_f32 v48, v48, v56
    v_add_f32 v49, v49, v57
    v_cvt_pk_bf16_f32 v49, v48, v49
    v_lshlrev_b32 v48, 16, v49
    v_and_b32 v49, 0xffff0000, v49
    v_add_f32 v48, v48, v24
    v_add_f32 v49, v49, v25
    s_waitcnt lgkmcnt(2)
    v_add_f32 v50, v50, v58
    v_add_f32 v51, v51, v59
    v_cvt_pk_bf16_f32 v51, v50, v51
    v_lshlrev_b32 v50, 16, v51
    v_and_b32 v51, 0xffff0000, v51
    v_add_f32 v50, v50, v26
    v_add_f32 v51, v51, v27
    v_cvt_pk_bf16_f32 v52, v44, v46
    v_cvt_pk_bf16_f32 v53, v48, v50
    buffer_store_dwordx2 v[52:53], v0, s[8:11], s55 offen offset:0
    v_cvt_pk_bf16_f32 v54, v45, v47
    v_cvt_pk_bf16_f32 v55, v49, v51
    buffer_store_dwordx2 v[54:55], v0, s[8:11], s55 offen offset:896
    v_mfma_f32_16x16x32_bf16 v[40:43], v[176:179], v[144:147], v[40:43]
    ds_read_b64 v[80:81], v16 offset:2624
    v_mfma_f32_16x16x32_bf16 v[40:43], v[180:183], v[148:151], v[40:43]
    ds_read_b64 v[82:83], v16 offset:2632
    v_mfma_f32_16x16x32_bf16 v[40:43], v[184:187], v[152:155], v[40:43]
    ds_read_b64 v[76:77], v16 offset:2688
    v_mfma_f32_16x16x32_bf16 v[40:43], v[188:191], v[156:159], v[40:43]
    ds_read_b64 v[78:79], v16 offset:2696
    v_mfma_f32_16x16x32_bf16 v[40:43], v[192:195], v[208:211], v[40:43]
    ds_read_b64 v[88:89], v16 offset:2752
    v_mfma_f32_16x16x32_bf16 v[40:43], v[196:199], v[216:219], v[40:43]
    ds_read_b64 v[90:91], v16 offset:2760
    v_mfma_f32_16x16x32_bf16 v[40:43], v[200:203], v[224:227], v[40:43]
    ds_read_b64 v[84:85], v16 offset:3072
    v_mfma_f32_16x16x32_bf16 v[40:43], v[204:207], v[232:235], v[40:43]
    ds_read_b64 v[86:87], v16 offset:3080
    v_mfma_f32_16x16x32_bf16 v[36:39], v[96:99], v[92:95], v[36:39]
    ds_read_b64 v[112:113], v16 offset:3136
    v_mfma_f32_16x16x32_bf16 v[36:39], v[100:103], v[64:67], v[36:39]
    ds_read_b64 v[114:115], v16 offset:3144
    v_mfma_f32_16x16x32_bf16 v[36:39], v[104:107], v[240:243], v[36:39]
    ds_read_b128 v[160:163], v17 offset:3648
    v_mfma_f32_16x16x32_bf16 v[36:39], v[108:111], v[72:75], v[36:39]
    ds_read_b64 v[120:121], v16 offset:3200
    s_waitcnt lgkmcnt(12)
    v_mfma_f32_16x16x32_bf16 v[36:39], v[116:119], v[244:247], v[36:39]
    ds_read_b64 v[122:123], v16 offset:3208
    s_waitcnt lgkmcnt(11)
    v_mfma_f32_16x16x32_bf16 v[36:39], v[124:127], v[80:83], v[36:39]
    ds_read_b128 v[164:167], v17 offset:3712
    s_waitcnt lgkmcnt(10)
    v_mfma_f32_16x16x32_bf16 v[36:39], v[132:135], v[76:79], v[36:39]
    ds_read_b64 v[128:129], v16 offset:3264
    s_waitcnt lgkmcnt(9)
    v_mfma_f32_16x16x32_bf16 v[36:39], v[140:143], v[88:91], v[36:39]
    ds_read_b64 v[130:131], v16 offset:3272
    v_mfma_f32_16x16x32_bf16 v[40:43], v[212:215], v[92:95], v[40:43]
    ds_read_b128 v[168:171], v17 offset:3776
    v_mfma_f32_16x16x32_bf16 v[40:43], v[220:223], v[64:67], v[40:43]
    ds_read_b64 v[136:137], v16 offset:3584
    v_mfma_f32_16x16x32_bf16 v[40:43], v[228:231], v[240:243], v[40:43]
    ds_read_b64 v[138:139], v16 offset:3592
    v_mfma_f32_16x16x32_bf16 v[40:43], v[236:239], v[72:75], v[40:43]
    ds_read_b64 v[172:173], v16 offset:3648
    v_mfma_f32_16x16x32_bf16 v[40:43], v[96:99], v[244:247], v[40:43]
    ds_read_b64 v[174:175], v16 offset:3656
    v_mfma_f32_16x16x32_bf16 v[40:43], v[100:103], v[80:83], v[40:43]
    ds_read_b64 v[144:145], v16 offset:3712
    v_mfma_f32_16x16x32_bf16 v[40:43], v[104:107], v[76:79], v[40:43]
    ds_read_b64 v[146:147], v16 offset:3720
    v_mfma_f32_16x16x32_bf16 v[40:43], v[108:111], v[88:91], v[40:43]
    ds_read_b64 v[176:177], v16 offset:3776
    s_waitcnt lgkmcnt(15)
    v_mfma_f32_16x16x32_bf16 v[36:39], v[68:71], v[84:87], v[36:39]
    ds_read_b64 v[178:179], v16 offset:3784
    s_waitcnt lgkmcnt(14)
    v_mfma_f32_16x16x32_bf16 v[36:39], v[160:163], v[112:115], v[36:39]
    s_waitcnt lgkmcnt(11)
    v_mfma_f32_16x16x32_bf16 v[36:39], v[164:167], v[120:123], v[36:39]
    s_waitcnt lgkmcnt(8)
    v_mfma_f32_16x16x32_bf16 v[36:39], v[168:171], v[128:131], v[36:39]
    s_nop 7
    ds_write_addtid_b32 v36 offset:4128
    ds_write_addtid_b32 v37 offset:12384
    ds_write_addtid_b32 v38 offset:20640
    ds_write_addtid_b32 v39 offset:28896
    ds_read_b32 v21, v19 offset:3584
    ds_read_b32 v23, v19 offset:20224
    ds_read_b32 v25, v19 offset:36864
    ds_read_b32 v27, v19 offset:53504
    s_waitcnt lgkmcnt(3)
    v_lshlrev_b32 v20, 16, v21
    v_and_b32 v21, 0xffff0000, v21
    v_mul_f32 v20, s40, v20
    v_mul_f32 v21, s40, v21
    v_cvt_pk_bf16_f32 v21, v20, v21
    v_lshlrev_b32 v20, 16, v21
    v_and_b32 v21, 0xffff0000, v21
    s_waitcnt lgkmcnt(2)
    v_lshlrev_b32 v22, 16, v23
    v_and_b32 v23, 0xffff0000, v23
    v_mul_f32 v22, s41, v22
    v_mul_f32 v23, s41, v23
    v_cvt_pk_bf16_f32 v23, v22, v23
    v_lshlrev_b32 v22, 16, v23
    v_and_b32 v23, 0xffff0000, v23
    s_waitcnt lgkmcnt(1)
    v_lshlrev_b32 v24, 16, v25
    v_and_b32 v25, 0xffff0000, v25
    v_mul_f32 v24, s42, v24
    v_mul_f32 v25, s42, v25
    v_cvt_pk_bf16_f32 v25, v24, v25
    v_lshlrev_b32 v24, 16, v25
    v_and_b32 v25, 0xffff0000, v25
    s_waitcnt lgkmcnt(0)
    v_lshlrev_b32 v26, 16, v27
    v_and_b32 v27, 0xffff0000, v27
    v_mul_f32 v26, s43, v26
    v_mul_f32 v27, s43, v27
    v_cvt_pk_bf16_f32 v27, v26, v27
    v_lshlrev_b32 v26, 16, v27
    v_and_b32 v27, 0xffff0000, v27
    s_barrier
    v_mfma_f32_16x16x32_bf16 v[40:43], v[116:119], v[84:87], v[40:43]
    v_mfma_f32_16x16x32_bf16 v[40:43], v[124:127], v[112:115], v[40:43]
    v_mfma_f32_16x16x32_bf16 v[40:43], v[132:135], v[120:123], v[40:43]
    v_mfma_f32_16x16x32_bf16 v[40:43], v[140:143], v[128:131], v[40:43]
    v_mfma_f32_16x16x32_bf16 v[40:43], v[68:71], v[136:139], v[40:43]
    v_mfma_f32_16x16x32_bf16 v[40:43], v[160:163], v[172:175], v[40:43]
    v_mfma_f32_16x16x32_bf16 v[40:43], v[164:167], v[144:147], v[40:43]
    v_mfma_f32_16x16x32_bf16 v[40:43], v[168:171], v[176:179], v[40:43]
    s_nop 7
    ds_write_addtid_b32 v40 offset:6192
    ds_write_addtid_b32 v41 offset:14448
    ds_write_addtid_b32 v42 offset:22704
    ds_write_addtid_b32 v43 offset:30960
    s_waitcnt lgkmcnt(0)
    s_barrier
    ds_read_b64 v[44:45], v18 offset:6192
    ds_read_b64 v[52:53], v18 offset:6704
    ds_read_b64 v[46:47], v18 offset:6448
    ds_read_b64 v[54:55], v18 offset:6960
    ds_read_b64 v[48:49], v18 offset:7216
    ds_read_b64 v[56:57], v18 offset:7728
    ds_read_b64 v[50:51], v18 offset:7472
    ds_read_b64 v[58:59], v18 offset:7984
    s_mov_b32 s55, 1605632
    s_waitcnt lgkmcnt(6)
    v_add_f32 v44, v44, v52
    v_add_f32 v45, v45, v53
    v_cvt_pk_bf16_f32 v45, v44, v45
    v_lshlrev_b32 v44, 16, v45
    v_and_b32 v45, 0xffff0000, v45
    v_add_f32 v44, v44, v20
    v_add_f32 v45, v45, v21
    s_waitcnt lgkmcnt(4)
    v_add_f32 v46, v46, v54
    v_add_f32 v47, v47, v55
    v_cvt_pk_bf16_f32 v47, v46, v47
    v_lshlrev_b32 v46, 16, v47
    v_and_b32 v47, 0xffff0000, v47
    v_add_f32 v46, v46, v22
    v_add_f32 v47, v47, v23
    s_waitcnt lgkmcnt(2)
    v_add_f32 v48, v48, v56
    v_add_f32 v49, v49, v57
    v_cvt_pk_bf16_f32 v49, v48, v49
    v_lshlrev_b32 v48, 16, v49
    v_and_b32 v49, 0xffff0000, v49
    v_add_f32 v48, v48, v24
    v_add_f32 v49, v49, v25
    s_waitcnt lgkmcnt(0)
    v_add_f32 v50, v50, v58
    v_add_f32 v51, v51, v59
    v_cvt_pk_bf16_f32 v51, v50, v51
    v_lshlrev_b32 v50, 16, v51
    v_and_b32 v51, 0xffff0000, v51
    v_add_f32 v50, v50, v26
    v_add_f32 v51, v51, v27
    v_cvt_pk_bf16_f32 v52, v44, v46
    v_cvt_pk_bf16_f32 v53, v48, v50
    buffer_store_dwordx2 v[52:53], v0, s[8:11], s55 offen offset:0
    v_cvt_pk_bf16_f32 v54, v45, v47
    v_cvt_pk_bf16_f32 v55, v49, v51
    buffer_store_dwordx2 v[54:55], v0, s[8:11], s55 offen offset:896
    s_endpgm
.p2align 6
L_t2:
    s_branch L_tback
    s_nop 0
L_cv2:
    s_setprio 1
    s_mul_i32 s48, s33, 4608
    s_add_u32 s48, s48, 130560
    v_and_b32 v46, 31, v1
    v_lshrrev_b32 v47, 5, v1
    v_lshlrev_b32 v250, 4, v46
    s_waitcnt lgkmcnt(7)
    v_mfma_f32_32x32x16_f16 v[224:239], v[192:195], v[128:131], 0
    v_lshl_add_u32 v250, v47, 3, v250
    s_add_u32 s3, s48, 4088
    v_sub_u32 v250, s3, v250
    v_lshlrev_b32 v251, 4, v1
    s_xor_b32 s3, s15, s34
    s_waitcnt lgkmcnt(6)
    v_mfma_f32_32x32x16_f16 v[224:239], v[196:199], v[132:135], v[224:239]
    s_lshl_b32 s3, s3, 2
    s_and_b32 s57, s32, 3
    s_add_u32 s3, s3, s57
    s_lshl_b32 s3, s3, 11
    s_add_u32 s3, s3, s96
    s_waitcnt lgkmcnt(5)
    v_mfma_f32_32x32x16_f16 v[224:239], v[200:203], v[136:139], v[224:239]
    s_sub_u32 s3, s3, 32768
    v_add_u32 v249, s3, v251
    s_add_u32 s3, s48, 1008
    v_sub_u32 v251, s3, v251
    v_and_b32 v46, 15, v1
    s_waitcnt lgkmcnt(4)
    v_mfma_f32_32x32x16_f16 v[224:239], v[204:207], v[140:143], v[224:239]
    v_and_b32 v47, 48, v1
    v_add_u32 v48, 1, v46
    v_and_b32 v49, 3, v48
    v_and_b32 v48, 28, v48
    v_mul_u32_u24 v49, 4160, v49
    s_waitcnt lgkmcnt(3)
    v_mfma_f32_32x32x16_f16 v[224:239], v[208:211], v[144:147], v[224:239]
    v_lshl_add_u32 v48, v48, 1, v47
    s_and_b32 s57, s32, 2
    s_lshl_b32 s57, s57, 7
    s_mul_i32 s3, s33, 16640
    s_add_u32 s3, s3, s57
    s_waitcnt lgkmcnt(2)
    v_mfma_f32_32x32x16_f16 v[224:239], v[212:215], v[148:151], v[224:239]
    s_add_u32 s3, s3, 64000
    v_add3_u32 v16, v48, v49, s3
    s_add_u32 s3, s48, s57
    s_add_u32 s3, s3, 480
    v_lshlrev_b32 v48, 5, v46
    s_waitcnt lgkmcnt(1)
    v_mfma_f32_32x32x16_f16 v[224:239], v[216:219], v[152:155], v[224:239]
    v_add_u32 v49, s3, v47
    v_sub_u32 v17, v49, v48
    s_mov_b32 s44, 0x05040100
    s_mov_b32 s45, 0x07060302
    s_waitcnt lgkmcnt(0)
    v_mfma_f32_32x32x16_f16 v[224:239], v[220:223], v[156:159], v[224:239]
    s_waitcnt vmcnt(5)
    v_readfirstlane_b32 s3, v248
    s_nop 1
    s_mul_i32 s3, s3, 0x9e3779b1
    s_add_u32 s3, s3, 0x7f4a7c15
    s_getreg_b32 s97, hwreg(HW_REG_XCC_ID)
    s_and_b32 s97, s97, 7
    s_add_u32 s97, s97, 1
    s_xor_b32 s97, s97, s3
    s_mov_b32 s99, s3
    v_mov_b32 v60, s97
    v_mul_f32 v224, v224, v43
    ds_write_addtid_b32 v224 offset:0
    v_mul_f32 v225, v225, v43
    ds_write_addtid_b32 v225 offset:2064
    v_mul_f32 v226, v226, v43
    ds_write_addtid_b32 v226 offset:4128
    v_mul_f32 v227, v227, v43
    ds_write_addtid_b32 v227 offset:6192
    v_mul_f32 v228, v228, v43
    ds_write_addtid_b32 v228 offset:8256
    v_mul_f32 v229, v229, v43
    ds_write_addtid_b32 v229 offset:10320
    v_mul_f32 v230, v230, v43
    ds_write_addtid_b32 v230 offset:12384
    v_mul_f32 v231, v231, v43
    ds_write_addtid_b32 v231 offset:14448
    v_mul_f32 v232, v232, v43
    ds_write_addtid_b32 v232 offset:16512
    v_mul_f32 v233, v233, v43
    ds_write_addtid_b32 v233 offset:18576
    v_mul_f32 v234, v234, v43
    ds_write_addtid_b32 v234 offset:20640
    v_mul_f32 v235, v235, v43
    ds_write_addtid_b32 v235 offset:22704
    v_mul_f32 v236, v236, v43
    ds_write_addtid_b32 v236 offset:24768
    s_setprio 0
    s_waitcnt vmcnt(2)
    s_add_u32 s3, s47, 61000
    s_mov_b32 m0, s3
    v_mov_b32_dpp v14, v12 wave_ror:1 row_mask:0xf bank_mask:0xf
    v_mov_b32_dpp v15, v13 wave_ror:1 row_mask:0xf bank_mask:0xf
    v_mov_b32_dpp v12, v6 wave_shr:1 row_mask:0xf bank_mask:0xf
    v_mov_b32_dpp v13, v7 wave_shr:1 row_mask:0xf bank_mask:0xf
    v_perm_b32 v44, v6, v4, s44
    v_perm_b32 v45, v4, v12, s44
    v_perm_b32 v46, v6, v4, s45
    v_perm_b32 v47, v4, v12, s45
    v_perm_b32 v48, v7, v5, s44
    v_perm_b32 v49, v5, v13, s44
    v_perm_b32 v50, v7, v5, s45
    v_perm_b32 v51, v5, v13, s45
    ds_write_addtid_b32 v44 offset:3032
    ds_write_addtid_b32 v44 offset:11348
    ds_write_addtid_b32 v45 offset:15504
    ds_write_addtid_b32 v45 offset:7188
    ds_write_addtid_b32 v46 offset:19672
    ds_write_addtid_b32 v46 offset:27988
    ds_write_addtid_b32 v47 offset:32144
    ds_write_addtid_b32 v47 offset:23828
    ds_write_addtid_b32 v48 offset:36312
    ds_write_addtid_b32 v48 offset:44628
    ds_write_addtid_b32 v49 offset:48784
    ds_write_addtid_b32 v49 offset:40468
    ds_write_addtid_b32 v50 offset:52952
    ds_write_addtid_b32 v50 offset:61268
    ds_write_addtid_b32 v51 offset:65424
    ds_write_addtid_b32 v51 offset:57108
    s_mov_b32 m0, s46
    s_waitcnt lgkmcnt(0)
    s_setprio 0
    s_barrier
    s_waitcnt vmcnt(0)
    s_add_u32 s3, s47, 62024
    s_mov_b32 m0, s3
    v_mov_b32_dpp v14, v10 wave_shr:1 row_mask:0xf bank_mask:0xf
    v_mov_b32_dpp v15, v11 wave_shr:1 row_mask:0xf bank_mask:0xf
    v_perm_b32 v44, v10, v8, s44
    v_perm_b32 v45, v8, v14, s44
    v_perm_b32 v46, v10, v8, s45
    v_perm_b32 v47, v8, v14, s45
    v_perm_b32 v48, v11, v9, s44
    v_perm_b32 v49, v9, v15, s44
    v_perm_b32 v50, v11, v9, s45
    v_perm_b32 v51, v9, v15, s45
    ds_write_addtid_b32 v44 offset:3032
    ds_write_addtid_b32 v44 offset:11348
    ds_write_addtid_b32 v45 offset:15504
    ds_write_addtid_b32 v45 offset:7188
    ds_write_addtid_b32 v46 offset:19672
    ds_write_addtid_b32 v46 offset:27988
    ds_write_addtid_b32 v47 offset:32144
    ds_write_addtid_b32 v47 offset:23828
    ds_write_addtid_b32 v48 offset:36312
    ds_write_addtid_b32 v48 offset:44628
    ds_write_addtid_b32 v49 offset:48784
    ds_write_addtid_b32 v49 offset:40468
    ds_write_addtid_b32 v50 offset:52952
    ds_write_addtid_b32 v50 offset:61268
    ds_write_addtid_b32 v51 offset:65424
    ds_write_addtid_b32 v51 offset:57108
    s_mov_b32 m0, s46
    ds_read_b64 v[64:65], v16 offset:0
    ds_read_b64 v[66:67], v16 offset:8
    ds_read_b64 v[68:69], v16 offset:64
    ds_read_b64 v[70:71], v16 offset:72
    ds_read_b64 v[72:73], v16 offset:128
    ds_read_b64 v[74:75], v16 offset:136
    ds_read_b64 v[76:77], v16 offset:192
    ds_read_b64 v[78:79], v16 offset:200
    s_waitcnt lgkmcnt(8)
    s_setprio 1
    s_barrier
    s_mov_b32 s58, 0
    v_mov_b32 v213, v60
    global_load_dwordx4 v[208:211], v249, s[62:63] nt
    s_mov_b64 exec, 1
    global_load_dwordx2 v[212:213], v249, s[62:63] offset:1024 nt
    s_mov_b64 exec, -1
    ds_read_b64 v[80:81], v16 offset:1024
    ds_read_b64 v[82:83], v16 offset:1032
    ds_read_b64 v[84:85], v16 offset:1088
    ds_read_b64 v[86:87], v16 offset:1096
    ds_read_b64 v[88:89], v16 offset:1152
    ds_read_b64 v[90:91], v16 offset:1160
    ds_read_b64 v[92:93], v16 offset:1216
    ds_read_b64 v[94:95], v16 offset:1224
    ds_read_b64 v[96:97], v16 offset:512
    ds_read_b64 v[98:99], v16 offset:520
    ds_read_b64 v[100:101], v16 offset:576
    ds_read_b64 v[102:103], v16 offset:584
    ds_read_b64 v[104:105], v16 offset:640
    ds_read_b64 v[106:107], v16 offset:648
    ds_read_b64 v[108:109], v16 offset:704
    ds_read_b64 v[110:111], v16 offset:712
    ds_read_b64 v[112:113], v16 offset:1536
    ds_read_b64 v[114:115], v16 offset:1544
    ds_read_b64 v[116:117], v16 offset:1600
    ds_read_b64 v[118:119], v16 offset:1608
    ds_read_b64 v[120:121], v16 offset:1664
    ds_read_b64 v[122:123], v16 offset:1672
    ds_read_b64 v[124:125], v16 offset:1728
    ds_read_b64 v[126:127], v16 offset:1736
    s_branch L_pw4
L_poll3:
    s_cmp_lg_u32 s58, 16
    s_cbranch_scc1 L_pt8
    v_xor_b32 v249, 0x2000, v249
L_pq7:
    global_load_dwordx4 v[208:211], v249, s[62:63] nt
    s_mov_b64 exec, 1
    global_load_dwordx2 v[212:213], v249, s[62:63] offset:1024 nt
    s_mov_b64 exec, -1
    s_waitcnt vmcnt(0)
    v_xor_b32 v240, v211, v60
    v_xor_b32 v241, v213, v60
    v_or_b32 v240, v240, v241
    v_cmp_ne_u32 vcc, 0, v240
    s_cbranch_vccnz L_pq7
    v_mov_b32 v211, s99
    v_mov_b32 v213, s99
    v_xor_b32 v249, 0x4000, v249
    global_store_dwordx4 v249, v[208:211], s[62:63] sc1
    s_mov_b64 exec, 1
    global_store_dwordx2 v249, v[212:213], s[62:63] offset:1024 sc1
    s_mov_b64 exec, -1
    s_waitcnt vmcnt(0)
    v_xor_b32 v249, 0x6000, v249
L_pt8:
    s_cmp_lt_u32 s58, 16
    s_cbranch_scc1 L_ps6
    v_xor_b32 v249, 0x4000, v249
    s_xor_b32 s3, s97, s99
    v_xor_b32 v60, s3, v60
L_ps6:
    v_mov_b32 v213, v60
    global_load_dwordx4 v[208:211], v249, s[62:63] sc1
    s_mov_b64 exec, 1
    global_load_dwordx2 v[212:213], v249, s[62:63] offset:1024 sc1
    s_mov_b64 exec, -1
L_pw4:
    s_waitcnt vmcnt(0)
    v_xor_b32 v240, v211, v60
    v_xor_b32 v241, v213, v60
    v_or_b32 v240, v240, v241
    v_cmp_ne_u32 vcc, 0, v240
    s_cbranch_vccz L_po5
    s_add_u32 s58, s58, 1
    s_cmp_lt_u32 s58, 2000000
    s_cbranch_scc1 L_poll3
L_po5:
    v_permlane32_swap_b32 v211, v210
    s_mov_b64 exec, 1
    v_mov_b32 v210, v212
    s_mov_b64 exec, -1
    v_lshlrev_b32 v224, 16, v208
    v_and_b32 v225, 0xffff0000, v208
    v_lshlrev_b32 v226, 16, v209
    v_and_b32 v227, 0xffff0000, v209
    v_lshlrev_b32 v228, 16, v210
    v_and_b32 v229, 0xffff0000, v210
    v_lshlrev_b32 v230, 16, v211
    v_and_b32 v231, 0xffff0000, v211
    v_cvt_pk_bf16_f32 v240, v227, v226
    v_cvt_pk_bf16_f32 v241, v225, v224
    v_mov_b32_dpp v242, v228 wave_rol:1 row_mask:0xf bank_mask:0xf
    ds_write_b64 v250, v[240:241]
    v_cvt_pk_bf16_f32 v245, v230, v230
    v_cvt_pk_bf16_f32 v246, v230, v229
    v_cvt_pk_bf16_f32 v247, v228, v228
    v_cvt_pk_bf16_f32 v244, v242, v231
    s_mov_b32 exec_lo, 0
    ds_write_b128 v251, v[244:247] offset:3072
    s_mov_b32 exec_lo, -1
    s_waitcnt lgkmcnt(0)
    s_setprio 1
    s_barrier
    ds_read_b128 v[128:131], v17 offset:3584
    ds_read_b128 v[132:135], v17 offset:3648
    ds_read_b128 v[136:139], v17 offset:3712
    ds_read_b128 v[140:143], v17 offset:3776
    v_mov_b32 v44, s96
    v_mov_b32 v45, s99
    s_mov_b64 exec, 1
    global_store_dword v44, v45, s[62:63]
    s_mov_b64 exec, -1
    s_waitcnt lgkmcnt(3)
    v_mfma_f32_16x16x32_bf16 v[28:31], v[128:131], v[64:67], 0
    ds_read_b128 v[144:147], v17 offset:3072
    s_waitcnt lgkmcnt(3)
    v_mfma_f32_16x16x32_bf16 v[28:31], v[132:135], v[68:71], v[28:31]
    ds_read_b128 v[148:151], v17 offset:3136
    s_waitcnt lgkmcnt(3)
    v_mfma_f32_16x16x32_bf16 v[28:31], v[136:139], v[72:75], v[28:31]
    ds_read_b128 v[152:155], v17 offset:3200
    s_waitcnt lgkmcnt(3)
    v_mfma_f32_16x16x32_bf16 v[28:31], v[140:143], v[76:79], v[28:31]
    ds_read_b128 v[156:159], v17 offset:3264
    v_mfma_f32_16x16x32_bf16 v[32:35], v[128:131], v[80:83], 0
    ds_read_b128 v[160:163], v17 offset:2560
    v_mfma_f32_16x16x32_bf16 v[32:35], v[132:135], v[84:87], v[32:35]
    ds_read_b128 v[164:167], v17 offset:2624
    v_mfma_f32_16x16x32_bf16 v[32:35], v[136:139], v[88:91], v[32:35]
    s_nop 1
    ds_write_addtid_b32 v28 offset:0
    v_mfma_f32_16x16x32_bf16 v[32:35], v[140:143], v[92:95], v[32:35]
    ds_read_b128 v[168:171], v17 offset:2688
    ds_write_addtid_b32 v29 offset:8256
    s_waitcnt lgkmcnt(8)
    v_mfma_f32_16x16x32_bf16 v[32:35], v[144:147], v[96:99], v[32:35]
    ds_read_b128 v[172:175], v17 offset:2752
    ds_write_addtid_b32 v30 offset:16512
    s_waitcnt lgkmcnt(9)
    v_mfma_f32_16x16x32_bf16 v[32:35], v[148:151], v[100:103], v[32:35]
    ds_read_b128 v[176:179], v17 offset:2048
    ds_write_addtid_b32 v31 offset:24768
    s_waitcnt lgkmcnt(10)
    v_mfma_f32_16x16x32_bf16 v[32:35], v[152:155], v[104:107], v[32:35]
    ds_read_b128 v[180:183], v17 offset:2112
    s_waitcnt lgkmcnt(1)
    s_barrier
    v_mfma_f32_16x16x32_bf16 v[32:35], v[156:159], v[108:111], v[32:35]
    ds_read_b128 v[184:187], v17 offset:2176
    v_mfma_f32_16x16x32_bf16 v[32:35], v[160:163], v[64:67], v[32:35]
    ds_read_b128 v[188:191], v17 offset:2240
    v_mfma_f32_16x16x32_bf16 v[32:35], v[164:167], v[68:71], v[32:35]
    ds_read_b128 v[192:195], v17 offset:1536
    v_mfma_f32_16x16x32_bf16 v[32:35], v[168:171], v[72:75], v[32:35]
    ds_read_b128 v[196:199], v17 offset:1600
    v_mfma_f32_16x16x32_bf16 v[32:35], v[172:175], v[76:79], v[32:35]
    ds_read_b128 v[200:203], v17 offset:1664
    v_mfma_f32_16x16x32_bf16 v[36:39], v[176:179], v[112:115], 0
    ds_read_b128 v[204:207], v17 offset:1728
    s_waitcnt lgkmcnt(6)
    v_mfma_f32_16x16x32_bf16 v[36:39], v[180:183], v[116:119], v[36:39]
    ds_read_b128 v[216:219], v17 offset:1024
    s_waitcnt lgkmcnt(6)
    v_mfma_f32_16x16x32_bf16 v[36:39], v[184:187], v[120:123], v[36:39]
    ds_read_b128 v[220:223], v17 offset:1088
    ds_write_addtid_b32 v32 offset:2064
    s_waitcnt lgkmcnt(7)
    v_mfma_f32_16x16x32_bf16 v[36:39], v[188:191], v[124:127], v[36:39]
    ds_read_b128 v[208:211], v17 offset:1152
    ds_write_addtid_b32 v33 offset:10320
    s_waitcnt lgkmcnt(8)
    v_mfma_f32_16x16x32_bf16 v[36:39], v[192:195], v[80:83], v[36:39]
    ds_read_b128 v[212:215], v17 offset:1216
    ds_write_addtid_b32 v34 offset:18576
    s_waitcnt lgkmcnt(9)
    v_mfma_f32_16x16x32_bf16 v[36:39], v[196:199], v[84:87], v[36:39]
    ds_read_b128 v[224:227], v17 offset:512
    ds_write_addtid_b32 v35 offset:26832
    s_waitcnt lgkmcnt(10)
    v_mfma_f32_16x16x32_bf16 v[36:39], v[200:203], v[88:91], v[36:39]
    ds_read_b128 v[228:231], v17 offset:576
    s_waitcnt lgkmcnt(1)
    s_barrier
    v_mfma_f32_16x16x32_bf16 v[36:39], v[204:207], v[92:95], v[36:39]
    ds_read_b128 v[232:235], v17 offset:640
    v_mfma_f32_16x16x32_bf16 v[36:39], v[216:219], v[96:99], v[36:39]
    ds_read_b128 v[236:239], v17 offset:704
    v_mfma_f32_16x16x32_bf16 v[36:39], v[220:223], v[100:103], v[36:39]
    ds_read_b64 v[240:241], v16 offset:2560
    ds_read_b64 v[242:243], v16 offset:2568
    v_mfma_f32_16x16x32_bf16 v[36:39], v[208:211], v[104:107], v[36:39]
    ds_read_b64 v[244:245], v16 offset:2624
    ds_read_b64 v[246:247], v16 offset:2632
    v_mfma_f32_16x16x32_bf16 v[36:39], v[212:215], v[108:111], v[36:39]
    ds_read_b64 v[248:249], v16 offset:2688
    ds_read_b64 v[250:251], v16 offset:2696
    v_mfma_f32_16x16x32_bf16 v[36:39], v[224:227], v[64:67], v[36:39]
    ds_read_b64 v[252:253], v16 offset:2752
    ds_read_b64 v[254:255], v16 offset:2760
    s_waitcnt lgkmcnt(10)
    v_mfma_f32_16x16x32_bf16 v[36:39], v[228:231], v[68:71], v[36:39]
    ds_read_b64 v[212:213], v16 offset:2048
    ds_read_b64 v[214:215], v16 offset:2056
    s_waitcnt lgkmcnt(11)
    v_mfma_f32_16x16x32_bf16 v[36:39], v[232:235], v[72:75], v[36:39]
    ds_read_b64 v[224:225], v16 offset:2112
    ds_read_b64 v[226:227], v16 offset:2120
    s_waitcnt lgkmcnt(12)
    v_mfma_f32_16x16x32_bf16 v[36:39], v[236:239], v[76:79], v[36:39]
    ds_read_b64 v[228:229], v16 offset:2176
    ds_read_b64 v[230:231], v16 offset:2184
    s_waitcnt lgkmcnt(12)
    v_mfma_f32_16x16x32_bf16 v[36:39], v[144:147], v[240:243], v[36:39]
    ds_read_b64 v[232:233], v16 offset:2240
    ds_read_b64 v[234:235], v16 offset:2248
    s_waitcnt lgkmcnt(12)
    v_mfma_f32_16x16x32_bf16 v[36:39], v[148:151], v[244:247], v[36:39]
    ds_read_b64 v[236:237], v16 offset:3072
    ds_read_b64 v[238:239], v16 offset:3080
    s_waitcnt lgkmcnt(12)
    v_mfma_f32_16x16x32_bf16 v[36:39], v[152:155], v[248:251], v[36:39]
    ds_read_b64 v[144:145], v16 offset:3136
    ds_read_b64 v[146:147], v16 offset:3144
    s_waitcnt lgkmcnt(12)
    v_mfma_f32_16x16x32_bf16 v[36:39], v[156:159], v[252:255], v[36:39]
    ds_read_b64 v[148:149], v16 offset:3200
    ds_read_b64 v[150:151], v16 offset:3208
    s_waitcnt lgkmcnt(12)
    v_mfma_f32_16x16x32_bf16 v[36:39], v[160:163], v[212:215], v[36:39]
    ds_read_b64 v[152:153], v16 offset:3264
    ds_read_b64 v[154:155], v16 offset:3272
    s_waitcnt lgkmcnt(12)
    v_mfma_f32_16x16x32_bf16 v[36:39], v[164:167], v[224:227], v[36:39]
    ds_read_b128 v[156:159], v17 offset:1216
    s_waitcnt lgkmcnt(11)
    v_mfma_f32_16x16x32_bf16 v[36:39], v[168:171], v[228:231], v[36:39]
    s_waitcnt lgkmcnt(9)
    v_mfma_f32_16x16x32_bf16 v[36:39], v[172:175], v[232:235], v[36:39]
    s_waitcnt lgkmcnt(7)
    v_mfma_f32_16x16x32_bf16 v[36:39], v[128:131], v[236:239], v[36:39]
    ds_read_b128 v[128:131], v17 offset:512
    s_waitcnt lgkmcnt(6)
    v_mfma_f32_16x16x32_bf16 v[36:39], v[132:135], v[144:147], v[36:39]
    ds_read_b128 v[132:135], v17 offset:576
    s_waitcnt lgkmcnt(5)
    v_mfma_f32_16x16x32_bf16 v[36:39], v[136:139], v[148:151], v[36:39]
    ds_read_b128 v[136:139], v17 offset:640
    s_waitcnt lgkmcnt(4)
    v_mfma_f32_16x16x32_bf16 v[36:39], v[140:143], v[152:155], v[36:39]
    v_mfma_f32_16x16x32_bf16 v[40:43], v[160:163], v[240:243], 0
    ds_read_b128 v[240:243], v17 offset:704
    v_mfma_f32_16x16x32_bf16 v[40:43], v[164:167], v[244:247], v[40:43]
    ds_read_b128 v[160:163], v17 offset:0
    v_mfma_f32_16x16x32_bf16 v[40:43], v[168:171], v[248:251], v[40:43]
    s_nop 2
    ds_write_addtid_b32 v36 offset:4128
    v_mfma_f32_16x16x32_bf16 v[40:43], v[172:175], v[252:255], v[40:43]
    ds_write_addtid_b32 v37 offset:12384
    v_mfma_f32_16x16x32_bf16 v[40:43], v[176:179], v[212:215], v[40:43]
    ds_write_addtid_b32 v38 offset:20640
    v_mfma_f32_16x16x32_bf16 v[40:43], v[180:183], v[224:227], v[40:43]
    ds_write_addtid_b32 v39 offset:28896
    v_mfma_f32_16x16x32_bf16 v[40:43], v[184:187], v[228:231], v[40:43]
    ds_read_b128 v[244:247], v17 offset:64
    s_waitcnt lgkmcnt(1)
    s_barrier
    v_mfma_f32_16x16x32_bf16 v[40:43], v[188:191], v[232:235], v[40:43]
    ds_read_b128 v[164:167], v17 offset:128
    v_mfma_f32_16x16x32_bf16 v[40:43], v[192:195], v[112:115], v[40:43]
    ds_read_b128 v[248:251], v17 offset:192
    v_mfma_f32_16x16x32_bf16 v[40:43], v[196:199], v[116:119], v[40:43]
    ds_read_b64 v[168:169], v16 offset:3584
    v_mfma_f32_16x16x32_bf16 v[40:43], v[200:203], v[120:123], v[40:43]
    ds_read_b64 v[170:171], v16 offset:3592
    v_mfma_f32_16x16x32_bf16 v[40:43], v[204:207], v[124:127], v[40:43]
    ds_read_b128 v[252:255], v17 offset:3584
    v_mfma_f32_16x16x32_bf16 v[40:43], v[216:219], v[80:83], v[40:43]
    ds_read_b64 v[172:173], v16 offset:3648
    v_mfma_f32_16x16x32_bf16 v[40:43], v[220:223], v[84:87], v[40:43]
    ds_read_b64 v[174:175], v16 offset:3656
    v_mfma_f32_16x16x32_bf16 v[40:43], v[208:211], v[88:91], v[40:43]
    ds_read_b128 v[212:215], v17 offset:3648
    v_mfma_f32_16x16x32_bf16 v[40:43], v[156:159], v[92:95], v[40:43]
    ds_read_b64 v[176:177], v16 offset:3712
    v_mfma_f32_16x16x32_bf16 v[40:43], v[128:131], v[96:99], v[40:43]
    ds_read_b64 v[178:179], v16 offset:3720
    v_mfma_f32_16x16x32_bf16 v[40:43], v[132:135], v[100:103], v[40:43]
    ds_read_b128 v[224:227], v17 offset:3712
    v_mfma_f32_16x16x32_bf16 v[40:43], v[136:139], v[104:107], v[40:43]
    ds_read_b64 v[180:181], v16 offset:3776
    v_mfma_f32_16x16x32_bf16 v[40:43], v[240:243], v[108:111], v[40:43]
    ds_read_b64 v[182:183], v16 offset:3784
    v_mfma_f32_16x16x32_bf16 v[40:43], v[160:163], v[64:67], v[40:43]
    ds_read_b128 v[228:231], v17 offset:3072
    s_waitcnt lgkmcnt(14)
    v_mfma_f32_16x16x32_bf16 v[40:43], v[244:247], v[68:71], v[40:43]
    ds_read_b128 v[184:187], v17 offset:3136
    s_waitcnt lgkmcnt(14)
    v_mfma_f32_16x16x32_bf16 v[40:43], v[164:167], v[72:75], v[40:43]
    ds_read_b128 v[232:235], v17 offset:3200
    s_waitcnt lgkmcnt(14)
    v_mfma_f32_16x16x32_bf16 v[40:43], v[248:251], v[76:79], v[40:43]
    ds_read_b128 v[188:191], v17 offset:3264
    s_waitcnt lgkmcnt(12)
    v_mfma_f32_16x16x32_bf16 v[40:43], v[252:255], v[168:171], v[40:43]
    s_waitcnt lgkmcnt(9)
    v_mfma_f32_16x16x32_bf16 v[40:43], v[212:215], v[172:175], v[40:43]
    s_waitcnt lgkmcnt(6)
    v_mfma_f32_16x16x32_bf16 v[40:43], v[224:227], v[176:179], v[40:43]
    s_waitcnt lgkmcnt(4)
    v_mfma_f32_16x16x32_bf16 v[40:43], v[140:143], v[180:183], v[40:43]
    s_waitcnt lgkmcnt(3)
    v_mfma_f32_16x16x32_bf16 v[40:43], v[228:231], v[236:239], v[40:43]
    s_waitcnt lgkmcnt(2)
    v_mfma_f32_16x16x32_bf16 v[40:43], v[184:187], v[144:147], v[40:43]
    s_waitcnt lgkmcnt(1)
    v_mfma_f32_16x16x32_bf16 v[40:43], v[232:235], v[148:151], v[40:43]
    s_waitcnt lgkmcnt(0)
    v_mfma_f32_16x16x32_bf16 v[40:43], v[188:191], v[152:155], v[40:43]
    s_nop 7
    ds_write_addtid_b32 v40 offset:6192
    ds_write_addtid_b32 v41 offset:14448
    ds_write_addtid_b32 v42 offset:22704
    ds_write_addtid_b32 v43 offset:30960
    s_waitcnt lgkmcnt(0)
    s_barrier
    s_endpgm
.p2align 6
L_t3:
    s_branch L_tback
    s_nop 0
L_cv3:
    s_setprio 1
    s_mul_i32 s48, s33, 4608
    s_add_u32 s48, s48, 130560
    v_and_b32 v46, 31, v1
    v_lshrrev_b32 v47, 5, v1
    v_lshlrev_b32 v250, 4, v46
    s_waitcnt lgkmcnt(7)
    v_mfma_f32_32x32x16_f16 v[224:239], v[192:195], v[128:131], 0
    v_lshl_add_u32 v250, v47, 3, v250
    s_add_u32 s3, s48, 4088
    v_sub_u32 v250, s3, v250
    v_lshlrev_b32 v251, 4, v1
    s_xor_b32 s3, s15, s34
    s_waitcnt lgkmcnt(6)
    v_mfma_f32_32x32x16_f16 v[224:239], v[196:199], v[132:135], v[224:239]
    s_lshl_b32 s3, s3, 2
    s_and_b32 s57, s32, 3
    s_add_u32 s3, s3, s57
    s_lshl_b32 s3, s3, 11
    s_add_u32 s3, s3, s96
    s_waitcnt lgkmcnt(5)
    v_mfma_f32_32x32x16_f16 v[224:239], v[200:203], v[136:139], v[224:239]
    s_sub_u32 s3, s3, 32768
    v_add_u32 v249, s3, v251
    s_add_u32 s3, s48, 1008
    v_sub_u32 v251, s3, v251
    v_and_b32 v46, 15, v1
    s_waitcnt lgkmcnt(4)
    v_mfma_f32_32x32x16_f16 v[224:239], v[204:207], v[140:143], v[224:239]
    v_and_b32 v47, 48, v1
    v_add_u32 v48, 1, v46
    v_and_b32 v49, 3, v48
    v_and_b32 v48, 28, v48
    v_mul_u32_u24 v49, 4160, v49
    s_waitcnt lgkmcnt(3)
    v_mfma_f32_32x32x16_f16 v[224:239], v[208:211], v[144:147], v[224:239]
    v_lshl_add_u32 v48, v48, 1, v47
    s_and_b32 s57, s32, 2
    s_lshl_b32 s57, s57, 7
    s_mul_i32 s3, s33, 16640
    s_add_u32 s3, s3, s57
    s_waitcnt lgkmcnt(2)
    v_mfma_f32_32x32x16_f16 v[224:239], v[212:215], v[148:151], v[224:239]
    s_add_u32 s3, s3, 64000
    v_add3_u32 v16, v48, v49, s3
    s_add_u32 s3, s48, s57
    s_add_u32 s3, s3, 480
    v_lshlrev_b32 v48, 5, v46
    s_waitcnt lgkmcnt(1)
    v_mfma_f32_32x32x16_f16 v[224:239], v[216:219], v[152:155], v[224:239]
    v_add_u32 v49, s3, v47
    v_sub_u32 v17, v49, v48
    s_mov_b32 s44, 0x05040100
    s_mov_b32 s45, 0x07060302
    s_waitcnt lgkmcnt(0)
    v_mfma_f32_32x32x16_f16 v[224:239], v[220:223], v[156:159], v[224:239]
    s_waitcnt vmcnt(5)
    v_readfirstlane_b32 s3, v248
    s_nop 1
    s_mul_i32 s3, s3, 0x9e3779b1
    s_add_u32 s3, s3, 0x7f4a7c15
    s_getreg_b32 s97, hwreg(HW_REG_XCC_ID)
    s_and_b32 s97, s97, 7
    s_add_u32 s97, s97, 1
    s_xor_b32 s97, s97, s3
    s_mov_b32 s99, s3
    v_mov_b32 v60, s97
    v_mul_f32 v224, v224, v43
    ds_write_addtid_b32 v224 offset:0
    v_mul_f32 v225, v225, v43
    ds_write_addtid_b32 v225 offset:2064
    v_mul_f32 v226, v226, v43
    ds_write_addtid_b32 v226 offset:4128
    v_mul_f32 v227, v227, v43
    ds_write_addtid_b32 v227 offset:6192
    v_mul_f32 v228, v228, v43
    ds_write_addtid_b32 v228 offset:8256
    v_mul_f32 v229, v229, v43
    ds_write_addtid_b32 v229 offset:10320
    v_mul_f32 v230, v230, v43
    ds_write_addtid_b32 v230 offset:12384
    v_mul_f32 v231, v231, v43
    ds_write_addtid_b32 v231 offset:14448
    v_mul_f32 v232, v232, v43
    ds_write_addtid_b32 v232 offset:16512
    v_mul_f32 v233, v233, v43
    ds_write_addtid_b32 v233 offset:18576
    v_mul_f32 v234, v234, v43
    ds_write_addtid_b32 v234 offset:20640
    v_mul_f32 v235, v235, v43
    ds_write_addtid_b32 v235 offset:22704
    v_mul_f32 v236, v236, v43
    ds_write_addtid_b32 v236 offset:24768
    s_setprio 0
    s_waitcnt vmcnt(2)
    s_add_u32 s3, s47, 61000
    s_mov_b32 m0, s3
    v_mov_b32_dpp v14, v12 wave_ror:1 row_mask:0xf bank_mask:0xf
    v_mov_b32_dpp v15, v13 wave_ror:1 row_mask:0xf bank_mask:0xf
    v_mov_b32_dpp v12, v6 wave_shr:1 row_mask:0xf bank_mask:0xf
    v_mov_b32_dpp v13, v7 wave_shr:1 row_mask:0xf bank_mask:0xf
    v_perm_b32 v44, v6, v4, s44
    v_perm_b32 v45, v4, v12, s44
    v_perm_b32 v46, v6, v4, s45
    v_perm_b32 v47, v4, v12, s45
    v_perm_b32 v48, v7, v5, s44
    v_perm_b32 v49, v5, v13, s44
    v_perm_b32 v50, v7, v5, s45
    v_perm_b32 v51, v5, v13, s45
    ds_write_addtid_b32 v44 offset:3032
    ds_write_addtid_b32 v44 offset:11348
    ds_write_addtid_b32 v45 offset:15504
    ds_write_addtid_b32 v45 offset:7188
    ds_write_addtid_b32 v46 offset:19672
    ds_write_addtid_b32 v46 offset:27988
    ds_write_addtid_b32 v47 offset:32144
    ds_write_addtid_b32 v47 offset:23828
    ds_write_addtid_b32 v48 offset:36312
    ds_write_addtid_b32 v48 offset:44628
    ds_write_addtid_b32 v49 offset:48784
    ds_write_addtid_b32 v49 offset:40468
    ds_write_addtid_b32 v50 offset:52952
    ds_write_addtid_b32 v50 offset:61268
    ds_write_addtid_b32 v51 offset:65424
    ds_write_addtid_b32 v51 offset:57108
    s_mov_b32 m0, s46
    s_waitcnt lgkmcnt(0)
    s_setprio 0
    s_barrier
    s_waitcnt vmcnt(0)
    s_add_u32 s3, s47, 62024
    s_mov_b32 m0, s3
    v_mov_b32_dpp v14, v10 wave_shr:1 row_mask:0xf bank_mask:0xf
    v_mov_b32_dpp v15, v11 wave_shr:1 row_mask:0xf bank_mask:0xf
    v_perm_b32 v44, v10, v8, s44
    v_perm_b32 v45, v8, v14, s44
    v_perm_b32 v46, v10, v8, s45
    v_perm_b32 v47, v8, v14, s45
    v_perm_b32 v48, v11, v9, s44
    v_perm_b32 v49, v9, v15, s44
    v_perm_b32 v50, v11, v9, s45
    v_perm_b32 v51, v9, v15, s45
    ds_write_addtid_b32 v44 offset:3032
    ds_write_addtid_b32 v44 offset:11348
    ds_write_addtid_b32 v45 offset:15504
    ds_write_addtid_b32 v45 offset:7188
    ds_write_addtid_b32 v46 offset:19672
    ds_write_addtid_b32 v46 offset:27988
    ds_write_addtid_b32 v47 offset:32144
    ds_write_addtid_b32 v47 offset:23828
    ds_write_addtid_b32 v48 offset:36312
    ds_write_addtid_b32 v48 offset:44628
    ds_write_addtid_b32 v49 offset:48784
    ds_write_addtid_b32 v49 offset:40468
    ds_write_addtid_b32 v50 offset:52952
    ds_write_addtid_b32 v50 offset:61268
    ds_write_addtid_b32 v51 offset:65424
    ds_write_addtid_b32 v51 offset:57108
    s_mov_b32 m0, s46
    ds_read_b64 v[64:65], v16 offset:0
    ds_read_b64 v[66:67], v16 offset:8
    ds_read_b64 v[68:69], v16 offset:64
    ds_read_b64 v[70:71], v16 offset:72
    ds_read_b64 v[72:73], v16 offset:128
    ds_read_b64 v[74:75], v16 offset:136
    ds_read_b64 v[76:77], v16 offset:192
    ds_read_b64 v[78:79], v16 offset:200
    s_waitcnt lgkmcnt(8)
    s_setprio 1
    s_barrier
    s_mov_b32 s58, 0
    v_mov_b32 v213, v60
    global_load_dwordx4 v[208:211], v249, s[62:63] nt
    ds_read_b64 v[80:81], v16 offset:1024
    ds_read_b64 v[82:83], v16 offset:1032
    ds_read_b64 v[84:85], v16 offset:1088
    ds_read_b64 v[86:87], v16 offset:1096
    ds_read_b64 v[88:89], v16 offset:1152
    ds_read_b64 v[90:91], v16 offset:1160
    ds_read_b64 v[92:93], v16 offset:1216
    ds_read_b64 v[94:95], v16 offset:1224
    ds_read_b64 v[96:97], v16 offset:512
    ds_read_b64 v[98:99], v16 offset:520
    ds_read_b64 v[100:101], v16 offset:576
    ds_read_b64 v[102:103], v16 offset:584
    ds_read_b64 v[104:105], v16 offset:640
    ds_read_b64 v[106:107], v16 offset:648
    ds_read_b64 v[108:109], v16 offset:704
    ds_read_b64 v[110:111], v16 offset:712
    ds_read_b64 v[112:113], v16 offset:1536
    ds_read_b64 v[114:115], v16 offset:1544
    ds_read_b64 v[116:117], v16 offset:1600
    ds_read_b64 v[118:119], v16 offset:1608
    ds_read_b64 v[120:121], v16 offset:1664
    ds_read_b64 v[122:123], v16 offset:1672
    ds_read_b64 v[124:125], v16 offset:1728
    ds_read_b64 v[126:127], v16 offset:1736
    s_branch L_pw10
L_poll9:
    s_cmp_lg_u32 s58, 16
    s_cbranch_scc1 L_pt14
    v_xor_b32 v249, 0x2000, v249
L_pq13:
    global_load_dwordx4 v[208:211], v249, s[62:63] nt
    s_waitcnt vmcnt(0)
    v_xor_b32 v240, v211, v60
    v_xor_b32 v241, v213, v60
    v_or_b32 v240, v240, v241
    v_cmp_ne_u32 vcc, 0, v240
    s_cbranch_vccnz L_pq13
    v_mov_b32 v211, s99
    v_mov_b32 v213, s99
    v_xor_b32 v249, 0x4000, v249
    global_store_dwordx4 v249, v[208:211], s[62:63] sc1
    s_waitcnt vmcnt(0)
    s_nop 0
    v_xor_b32 v249, 0x6000, v249
L_pt14:
    s_cmp_lt_u32 s58, 16
    s_cbranch_scc1 L_ps12
    v_xor_b32 v249, 0x4000, v249
    s_xor_b32 s3, s97, s99
    v_xor_b32 v60, s3, v60
L_ps12:
    v_mov_b32 v213, v60
    global_load_dwordx4 v[208:211], v249, s[62:63] sc1
L_pw10:
    s_waitcnt vmcnt(0)
    v_xor_b32 v240, v211, v60
    v_xor_b32 v241, v213, v60
    v_or_b32 v240, v240, v241
    v_cmp_ne_u32 vcc, 0, v240
    s_cbranch_vccz L_po11
    s_add_u32 s58, s58, 1
    s_cmp_lt_u32 s58, 2000000
    s_cbranch_scc1 L_poll9
L_po11:
    v_lshlrev_b32 v232, 16, v208
    v_and_b32 v233, 0xffff0000, v208
    v_lshlrev_b32 v234, 16, v209
    v_and_b32 v235, 0xffff0000, v209
    v_lshlrev_b32 v236, 16, v210
    s_mov_b32 vcc_lo, 0xaaaaaaaa
    s_mov_b32 vcc_hi, 0xaaaaaaaa
    v_mov_b32_dpp v240, v234 wave_rol:1 row_mask:0xf bank_mask:0xf
    v_cvt_pk_bf16_f32 v225, v233, v233
    v_cvt_pk_bf16_f32 v226, v233, v232
    v_mov_b32_dpp v240, v232 wave_shl:1 row_mask:0xf bank_mask:0xf
    v_cvt_pk_bf16_f32 v227, v232, v232
    v_mov_b32_dpp v241, v235 wave_rol:1 row_mask:0xf bank_mask:0xf
    v_cvt_pk_bf16_f32 v224, v240, v240
    v_mov_b32_dpp v242, v236 wave_rol:1 row_mask:0xf bank_mask:0xf
    ds_write_b128 v251, v[224:227] offset:2048
    v_mov_b32_dpp v241, v234 wave_shl:1 row_mask:0xf bank_mask:0xf
    v_mov_b32_dpp v242, v235 wave_shl:1 row_mask:0xf bank_mask:0xf
    v_cndmask_b32 v243, v234, v241, vcc
    v_cvt_pk_bf16_f32 v230, v234, v234
    v_cvt_pk_bf16_f32 v231, v234, v234
    v_cvt_pk_bf16_f32 v228, v241, v241
    v_cvt_pk_bf16_f32 v229, v241, v243
    ds_write_b128 v251, v[228:231] offset:1024
    v_cndmask_b32 v243, v235, v242, vcc
    v_cvt_pk_bf16_f32 v246, v235, v235
    v_cvt_pk_bf16_f32 v247, v235, v235
    v_cvt_pk_bf16_f32 v244, v242, v242
    v_cvt_pk_bf16_f32 v245, v242, v243
    ds_write_b128 v251, v[244:247] offset:0
    s_waitcnt lgkmcnt(0)
    s_setprio 1
    s_barrier
    ds_read_b128 v[128:131], v17 offset:3584
    ds_read_b128 v[132:135], v17 offset:3648
    ds_read_b128 v[136:139], v17 offset:3712
    ds_read_b128 v[140:143], v17 offset:3776
    s_waitcnt lgkmcnt(3)
    v_mfma_f32_16x16x32_bf16 v[28:31], v[128:131], v[64:67], 0
    ds_read_b128 v[144:147], v17 offset:3072
    s_waitcnt lgkmcnt(3)
    v_mfma_f32_16x16x32_bf16 v[28:31], v[132:135], v[68:71], v[28:31]
    ds_read_b128 v[148:151], v17 offset:3136
    s_waitcnt lgkmcnt(3)
    v_mfma_f32_16x16x32_bf16 v[28:31], v[136:139], v[72:75], v[28:31]
    ds_read_b128 v[152:155], v17 offset:3200
    s_waitcnt lgkmcnt(3)
    v_mfma_f32_16x16x32_bf16 v[28:31], v[140:143], v[76:79], v[28:31]
    ds_read_b128 v[156:159], v17 offset:3264
    v_mfma_f32_16x16x32_bf16 v[32:35], v[128:131], v[80:83], 0
    ds_read_b128 v[160:163], v17 offset:2560
    v_mfma_f32_16x16x32_bf16 v[32:35], v[132:135], v[84:87], v[32:35]
    ds_read_b128 v[164:167], v17 offset:2624
    v_mfma_f32_16x16x32_bf16 v[32:35], v[136:139], v[88:91], v[32:35]
    s_nop 1
    ds_write_addtid_b32 v28 offset:0
    v_mfma_f32_16x16x32_bf16 v[32:35], v[140:143], v[92:95], v[32:35]
    ds_read_b128 v[168:171], v17 offset:2688
    ds_write_addtid_b32 v29 offset:8256
    s_waitcnt lgkmcnt(8)
    v_mfma_f32_16x16x32_bf16 v[32:35], v[144:147], v[96:99], v[32:35]
    ds_read_b128 v[172:175], v17 offset:2752
    ds_write_addtid_b32 v30 offset:16512
    s_waitcnt lgkmcnt(9)
    v_mfma_f32_16x16x32_bf16 v[32:35], v[148:151], v[100:103], v[32:35]
    ds_read_b128 v[176:179], v17 offset:2048
    ds_write_addtid_b32 v31 offset:24768
    s_waitcnt lgkmcnt(10)
    v_mfma_f32_16x16x32_bf16 v[32:35], v[152:155], v[104:107], v[32:35]
    ds_read_b128 v[180:183], v17 offset:2112
    s_waitcnt lgkmcnt(1)
    s_barrier
    v_mfma_f32_16x16x32_bf16 v[32:35], v[156:159], v[108:111], v[32:35]
    ds_read_b128 v[184:187], v17 offset:2176
    v_mfma_f32_16x16x32_bf16 v[32:35], v[160:163], v[64:67], v[32:35]
    ds_read_b128 v[188:191], v17 offset:2240
    v_mfma_f32_16x16x32_bf16 v[32:35], v[164:167], v[68:71], v[32:35]
    ds_read_b128 v[192:195], v17 offset:1536
    v_mfma_f32_16x16x32_bf16 v[32:35], v[168:171], v[72:75], v[32:35]
    ds_read_b128 v[196:199], v17 offset:1600
    v_mfma_f32_16x16x32_bf16 v[32:35], v[172:175], v[76:79], v[32:35]
    ds_read_b128 v[200:203], v17 offset:1664
    v_mfma_f32_16x16x32_bf16 v[36:39], v[176:179], v[112:115], 0
    ds_read_b128 v[204:207], v17 offset:1728
    s_waitcnt lgkmcnt(6)
    v_mfma_f32_16x16x32_bf16 v[36:39], v[180:183], v[116:119], v[36:39]
    ds_read_b128 v[216:219], v17 offset:1024
    s_waitcnt lgkmcnt(6)
    v_mfma_f32_16x16x32_bf16 v[36:39], v[184:187], v[120:123], v[36:39]
    ds_read_b128 v[220:223], v17 offset:1088
    ds_write_addtid_b32 v32 offset:2064
    s_waitcnt lgkmcnt(7)
    v_mfma_f32_16x16x32_bf16 v[36:39], v[188:191], v[124:127], v[36:39]
    ds_read_b128 v[208:211], v17 offset:1152
    ds_write_addtid_b32 v33 offset:10320
    s_waitcnt lgkmcnt(8)
    v_mfma_f32_16x16x32_bf16 v[36:39], v[192:195], v[80:83], v[36:39]
    ds_read_b128 v[212:215], v17 offset:1216
    ds_write_addtid_b32 v34 offset:18576
    s_waitcnt lgkmcnt(9)
    v_mfma_f32_16x16x32_bf16 v[36:39], v[196:199], v[84:87], v[36:39]
    ds_read_b128 v[224:227], v17 offset:512
    ds_write_addtid_b32 v35 offset:26832
    s_waitcnt lgkmcnt(10)
    v_mfma_f32_16x16x32_bf16 v[36:39], v[200:203], v[88:91], v[36:39]
    ds_read_b128 v[228:231], v17 offset:576
    s_waitcnt lgkmcnt(1)
    s_barrier
    v_mfma_f32_16x16x32_bf16 v[36:39], v[204:207], v[92:95], v[36:39]
    ds_read_b128 v[232:235], v17 offset:640
    v_mfma_f32_16x16x32_bf16 v[36:39], v[216:219], v[96:99], v[36:39]
    ds_read_b128 v[236:239], v17 offset:704
    v_mfma_f32_16x16x32_bf16 v[36:39], v[220:223], v[100:103], v[36:39]
    ds_read_b64 v[240:241], v16 offset:2560
    ds_read_b64 v[242:243], v16 offset:2568
    v_mfma_f32_16x16x32_bf16 v[36:39], v[208:211], v[104:107], v[36:39]
    ds_read_b64 v[244:245], v16 offset:2624
    ds_read_b64 v[246:247], v16 offset:2632
    v_mfma_f32_16x16x32_bf16 v[36:39], v[212:215], v[108:111], v[36:39]
    ds_read_b64 v[248:249], v16 offset:2688
    ds_read_b64 v[250:251], v16 offset:2696
    v_mfma_f32_16x16x32_bf16 v[36:39], v[224:227], v[64:67], v[36:39]
    ds_read_b64 v[252:253], v16 offset:2752
    ds_read_b64 v[254:255], v16 offset:2760
    s_waitcnt lgkmcnt(10)
    v_mfma_f32_16x16x32_bf16 v[36:39], v[228:231], v[68:71], v[36:39]
    ds_read_b64 v[212:213], v16 offset:2048
    ds_read_b64 v[214:215], v16 offset:2056
    s_waitcnt lgkmcnt(11)
    v_mfma_f32_16x16x32_bf16 v[36:39], v[232:235], v[72:75], v[36:39]
    ds_read_b64 v[224:225], v16 offset:2112
    ds_read_b64 v[226:227], v16 offset:2120
    s_waitcnt lgkmcnt(12)
    v_mfma_f32_16x16x32_bf16 v[36:39], v[236:239], v[76:79], v[36:39]
    ds_read_b64 v[228:229], v16 offset:2176
    ds_read_b64 v[230:231], v16 offset:2184
    s_waitcnt lgkmcnt(12)
    v_mfma_f32_16x16x32_bf16 v[36:39], v[144:147], v[240:243], v[36:39]
    ds_read_b64 v[232:233], v16 offset:2240
    ds_read_b64 v[234:235], v16 offset:2248
    s_waitcnt lgkmcnt(12)
    v_mfma_f32_16x16x32_bf16 v[36:39], v[148:151], v[244:247], v[36:39]
    ds_read_b64 v[236:237], v16 offset:3072
    ds_read_b64 v[238:239], v16 offset:3080
    s_waitcnt lgkmcnt(12)
    v_mfma_f32_16x16x32_bf16 v[36:39], v[152:155], v[248:251], v[36:39]
    ds_read_b64 v[144:145], v16 offset:3136
    ds_read_b64 v[146:147], v16 offset:3144
    s_waitcnt lgkmcnt(12)
    v_mfma_f32_16x16x32_bf16 v[36:39], v[156:159], v[252:255], v[36:39]
    ds_read_b64 v[148:149], v16 offset:3200
    ds_read_b64 v[150:151], v16 offset:3208
    s_waitcnt lgkmcnt(12)
    v_mfma_f32_16x16x32_bf16 v[36:39], v[160:163], v[212:215], v[36:39]
    ds_read_b64 v[152:153], v16 offset:3264
    ds_read_b64 v[154:155], v16 offset:3272
    s_waitcnt lgkmcnt(12)
    v_mfma_f32_16x16x32_bf16 v[36:39], v[164:167], v[224:227], v[36:39]
    ds_read_b128 v[156:159], v17 offset:1216
    s_waitcnt lgkmcnt(11)
    v_mfma_f32_16x16x32_bf16 v[36:39], v[168:171], v[228:231], v[36:39]
    s_waitcnt lgkmcnt(9)
    v_mfma_f32_16x16x32_bf16 v[36:39], v[172:175], v[232:235], v[36:39]
    s_waitcnt lgkmcnt(7)
    v_mfma_f32_16x16x32_bf16 v[36:39], v[128:131], v[236:239], v[36:39]
    ds_read_b128 v[128:131], v17 offset:512
    s_waitcnt lgkmcnt(6)
    v_mfma_f32_16x16x32_bf16 v[36:39], v[132:135], v[144:147], v[36:39]
    ds_read_b128 v[132:135], v17 offset:576
    s_waitcnt lgkmcnt(5)
    v_mfma_f32_16x16x32_bf16 v[36:39], v[136:139], v[148:151], v[36:39]
    ds_read_b128 v[136:139], v17 offset:640
    s_waitcnt lgkmcnt(4)
    v_mfma_f32_16x16x32_bf16 v[36:39], v[140:143], v[152:155], v[36:39]
    v_mfma_f32_16x16x32_bf16 v[40:43], v[160:163], v[240:243], 0
    ds_read_b128 v[240:243], v17 offset:704
    v_mfma_f32_16x16x32_bf16 v[40:43], v[164:167], v[244:247], v[40:43]
    ds_read_b128 v[160:163], v17 offset:0
    v_mfma_f32_16x16x32_bf16 v[40:43], v[168:171], v[248:251], v[40:43]
    s_nop 2
    ds_write_addtid_b32 v36 offset:4128
    v_mfma_f32_16x16x32_bf16 v[40:43], v[172:175], v[252:255], v[40:43]
    ds_write_addtid_b32 v37 offset:12384
    v_mfma_f32_16x16x32_bf16 v[40:43], v[176:179], v[212:215], v[40:43]
    ds_write_addtid_b32 v38 offset:20640
    v_mfma_f32_16x16x32_bf16 v[40:43], v[180:183], v[224:227], v[40:43]
    ds_write_addtid_b32 v39 offset:28896
    v_mfma_f32_16x16x32_bf16 v[40:43], v[184:187], v[228:231], v[40:43]
    ds_read_b128 v[244:247], v17 offset:64
    s_waitcnt lgkmcnt(1)
    s_barrier
    v_mfma_f32_16x16x32_bf16 v[40:43], v[188:191], v[232:235], v[40:43]
    ds_read_b128 v[164:167], v17 offset:128
    v_mfma_f32_16x16x32_bf16 v[40:43], v[192:195], v[112:115], v[40:43]
    ds_read_b128 v[248:251], v17 offset:192
    v_mfma_f32_16x16x32_bf16 v[40:43], v[196:199], v[116:119], v[40:43]
    ds_read_b64 v[168:169], v16 offset:3584
    v_mfma_f32_16x16x32_bf16 v[40:43], v[200:203], v[120:123], v[40:43]
    ds_read_b64 v[170:171], v16 offset:3592
    v_mfma_f32_16x16x32_bf16 v[40:43], v[204:207], v[124:127], v[40:43]
    ds_read_b128 v[252:255], v17 offset:3584
    v_mfma_f32_16x16x32_bf16 v[40:43], v[216:219], v[80:83], v[40:43]
    ds_read_b64 v[172:173], v16 offset:3648
    v_mfma_f32_16x16x32_bf16 v[40:43], v[220:223], v[84:87], v[40:43]
    ds_read_b64 v[174:175], v16 offset:3656
    v_mfma_f32_16x16x32_bf16 v[40:43], v[208:211], v[88:91], v[40:43]
    ds_read_b128 v[212:215], v17 offset:3648
    v_mfma_f32_16x16x32_bf16 v[40:43], v[156:159], v[92:95], v[40:43]
    ds_read_b64 v[176:177], v16 offset:3712
    v_mfma_f32_16x16x32_bf16 v[40:43], v[128:131], v[96:99], v[40:43]
    ds_read_b64 v[178:179], v16 offset:3720
    v_mfma_f32_16x16x32_bf16 v[40:43], v[132:135], v[100:103], v[40:43]
    ds_read_b128 v[224:227], v17 offset:3712
    v_mfma_f32_16x16x32_bf16 v[40:43], v[136:139], v[104:107], v[40:43]
    ds_read_b64 v[180:181], v16 offset:3776
    v_mfma_f32_16x16x32_bf16 v[40:43], v[240:243], v[108:111], v[40:43]
    ds_read_b64 v[182:183], v16 offset:3784
    v_mfma_f32_16x16x32_bf16 v[40:43], v[160:163], v[64:67], v[40:43]
    ds_read_b128 v[228:231], v17 offset:3072
    s_waitcnt lgkmcnt(14)
    v_mfma_f32_16x16x32_bf16 v[40:43], v[244:247], v[68:71], v[40:43]
    ds_read_b128 v[184:187], v17 offset:3136
    s_waitcnt lgkmcnt(14)
    v_mfma_f32_16x16x32_bf16 v[40:43], v[164:167], v[72:75], v[40:43]
    ds_read_b128 v[232:235], v17 offset:3200
    s_waitcnt lgkmcnt(14)
    v_mfma_f32_16x16x32_bf16 v[40:43], v[248:251], v[76:79], v[40:43]
    ds_read_b128 v[188:191], v17 offset:3264
    s_waitcnt lgkmcnt(12)
    v_mfma_f32_16x16x32_bf16 v[40:43], v[252:255], v[168:171], v[40:43]
    s_waitcnt lgkmcnt(9)
    v_mfma_f32_16x16x32_bf16 v[40:43], v[212:215], v[172:175], v[40:43]
    s_waitcnt lgkmcnt(6)
    v_mfma_f32_16x16x32_bf16 v[40:43], v[224:227], v[176:179], v[40:43]
    s_waitcnt lgkmcnt(4)
    v_mfma_f32_16x16x32_bf16 v[40:43], v[140:143], v[180:183], v[40:43]
    s_waitcnt lgkmcnt(3)
    v_mfma_f32_16x16x32_bf16 v[40:43], v[228:231], v[236:239], v[40:43]
    s_waitcnt lgkmcnt(2)
    v_mfma_f32_16x16x32_bf16 v[40:43], v[184:187], v[144:147], v[40:43]
    s_waitcnt lgkmcnt(1)
    v_mfma_f32_16x16x32_bf16 v[40:43], v[232:235], v[148:151], v[40:43]
    s_waitcnt lgkmcnt(0)
    v_mfma_f32_16x16x32_bf16 v[40:43], v[188:191], v[152:155], v[40:43]
    s_nop 7
    ds_write_addtid_b32 v40 offset:6192
    ds_write_addtid_b32 v41 offset:14448
    ds_write_addtid_b32 v42 offset:22704
    ds_write_addtid_b32 v43 offset:30960
    s_waitcnt lgkmcnt(0)
    s_barrier
    s_endpgm
.p2align 6
L_t4:
    s_branch L_tback
    s_nop 0
L_cv4:
    s_setprio 0
    s_mul_i32 s48, s33, 4608
    s_add_u32 s48, s48, 130560
    v_and_b32 v46, 31, v1
    v_lshrrev_b32 v47, 5, v1
    v_lshlrev_b32 v250, 4, v46
    s_waitcnt lgkmcnt(7)
    v_mfma_f32_32x32x16_f16 v[224:239], v[192:195], v[128:131], 0
    v_lshl_add_u32 v250, v47, 3, v250
    s_add_u32 s3, s48, 4088
    v_sub_u32 v250, s3, v250
    v_lshlrev_b32 v251, 4, v1
    s_xor_b32 s3, s15, s34
    s_waitcnt lgkmcnt(6)
    v_mfma_f32_32x32x16_f16 v[224:239], v[196:199], v[132:135], v[224:239]
    s_lshl_b32 s3, s3, 2
    s_and_b32 s57, s32, 3
    s_add_u32 s3, s3, s57
    s_lshl_b32 s3, s3, 11
    s_add_u32 s3, s3, s96
    s_waitcnt lgkmcnt(5)
    v_mfma_f32_32x32x16_f16 v[224:239], v[200:203], v[136:139], v[224:239]
    s_sub_u32 s3, s3, 32768
    v_add_u32 v249, s3, v251
    s_add_u32 s3, s48, 1008
    v_sub_u32 v251, s3, v251
    v_and_b32 v46, 15, v1
    s_waitcnt lgkmcnt(4)
    v_mfma_f32_32x32x16_f16 v[224:239], v[204:207], v[140:143], v[224:239]
    v_and_b32 v47, 48, v1
    v_add_u32 v48, 1, v46
    v_and_b32 v49, 3, v48
    v_and_b32 v48, 28, v48
    v_mul_u32_u24 v49, 4160, v49
    s_waitcnt lgkmcnt(3)
    v_mfma_f32_32x32x16_f16 v[224:239], v[208:211], v[144:147], v[224:239]
    v_lshl_add_u32 v48, v48, 1, v47
    s_and_b32 s57, s32, 2
    s_lshl_b32 s57, s57, 7
    s_mul_i32 s3, s33, 16640
    s_add_u32 s3, s3, s57
    s_waitcnt lgkmcnt(2)
    v_mfma_f32_32x32x16_f16 v[224:239], v[212:215], v[148:151], v[224:239]
    s_add_u32 s3, s3, 64000
    v_add3_u32 v16, v48, v49, s3
    s_add_u32 s3, s48, s57
    s_add_u32 s3, s3, 480
    v_lshlrev_b32 v48, 5, v46
    s_waitcnt lgkmcnt(1)
    v_mfma_f32_32x32x16_f16 v[224:239], v[216:219], v[152:155], v[224:239]
    v_add_u32 v49, s3, v47
    v_sub_u32 v17, v49, v48
    s_mov_b32 s44, 0x05040100
    s_mov_b32 s45, 0x07060302
    s_waitcnt lgkmcnt(0)
    v_mfma_f32_32x32x16_f16 v[224:239], v[220:223], v[156:159], v[224:239]
    s_waitcnt vmcnt(1)
    v_readfirstlane_b32 s3, v248
    s_nop 1
    s_mul_i32 s3, s3, 0x9e3779b1
    s_add_u32 s3, s3, 0x7f4a7c15
    s_getreg_b32 s97, hwreg(HW_REG_XCC_ID)
    s_and_b32 s97, s97, 7
    s_add_u32 s97, s97, 1
    s_xor_b32 s97, s97, s3
    s_mov_b32 s99, s3
    v_mov_b32 v60, s97
    v_mul_f32 v232, v232, v43
    ds_write_addtid_b32 v232 offset:16512
    v_mul_f32 v233, v233, v43
    ds_write_addtid_b32 v233 offset:18576
    v_mul_f32 v234, v234, v43
    ds_write_addtid_b32 v234 offset:20640
    v_mul_f32 v235, v235, v43
    ds_write_addtid_b32 v235 offset:22704
    v_mul_f32 v236, v236, v43
    ds_write_addtid_b32 v236 offset:24768
    s_mov_b32 m0, s53
    s_waitcnt lgkmcnt(0)
    s_setprio 2
    s_barrier
    ds_read_addtid_b32 v160 offset:512
    ds_read_addtid_b32 v161 offset:2576
    ds_read_addtid_b32 v162 offset:4640
    ds_read_addtid_b32 v163 offset:6704
    ds_read_addtid_b32 v164 offset:8768
    ds_read_addtid_b32 v165 offset:10832
    ds_read_addtid_b32 v166 offset:12896
    ds_read_addtid_b32 v167 offset:14960
    ds_read_addtid_b32 v168 offset:1024
    ds_read_addtid_b32 v169 offset:3088
    ds_read_addtid_b32 v170 offset:5152
    ds_read_addtid_b32 v171 offset:7216
    ds_read_addtid_b32 v172 offset:9280
    ds_read_addtid_b32 v173 offset:11344
    ds_read_addtid_b32 v174 offset:13408
    ds_read_addtid_b32 v175 offset:15472
    ds_read_addtid_b32 v176 offset:1536
    ds_read_addtid_b32 v177 offset:3600
    ds_read_addtid_b32 v178 offset:5664
    ds_read_addtid_b32 v179 offset:7728
    ds_read_addtid_b32 v180 offset:9792
    ds_read_addtid_b32 v181 offset:11856
    ds_read_addtid_b32 v182 offset:13920
    ds_read_addtid_b32 v183 offset:15984
    s_mov_b32 m0, s46
    v_mov_b32 v187, v60
    v_mov_b32 v189, v60
    s_waitcnt lgkmcnt(15)
    v_fma_f32 v224, v224, v43, v160
    v_fma_f32 v225, v225, v43, v161
    v_fma_f32 v226, v226, v43, v162
    v_fma_f32 v227, v227, v43, v163
    v_fma_f32 v228, v228, v43, v164
    v_fma_f32 v229, v229, v43, v165
    v_fma_f32 v230, v230, v43, v166
    v_fma_f32 v231, v231, v43, v167
    s_waitcnt lgkmcnt(8)
    v_add_f32 v224, v224, v168
    v_add_f32 v225, v225, v169
    v_add_f32 v226, v226, v170
    v_add_f32 v227, v227, v171
    v_add_f32 v228, v228, v172
    v_add_f32 v229, v229, v173
    v_add_f32 v230, v230, v174
    v_add_f32 v231, v231, v175
    s_waitcnt lgkmcnt(0)
    v_add_f32 v224, v224, v176
    v_add_f32 v225, v225, v177
    v_add_f32 v226, v226, v178
    v_add_f32 v227, v227, v179
    v_add_f32 v228, v228, v180
    v_add_f32 v229, v229, v181
    v_add_f32 v230, v230, v182
    v_add_f32 v231, v231, v183
    v_cvt_pk_bf16_f32 v186, v228, v229
    v_cvt_pk_bf16_f32 v190, v230, v231
    v_cvt_pk_bf16_f32 v184, v224, v225
    v_mov_b32 v188, v186
    v_cvt_pk_bf16_f32 v185, v226, v227
    v_permlane32_swap_b32 v190, v186
    global_store_dwordx4 v249, v[184:187], s[62:63]
    s_mov_b64 exec, 1
    global_store_dwordx2 v249, v[188:189], s[62:63] offset:1024
    s_mov_b64 exec, -1
    buffer_load_dwordx2 v[4:5], v2, s[4:7], 0 offen offset:0
    v_cvt_pk_bf16_f32 v240, v227, v226
    v_cvt_pk_bf16_f32 v241, v225, v224
    v_mov_b32_dpp v242, v228 wave_rol:1 row_mask:0xf bank_mask:0xf
    ds_write_b64 v250, v[240:241]
    v_cvt_pk_bf16_f32 v245, v230, v230
    v_cvt_pk_bf16_f32 v246, v230, v229
    v_cvt_pk_bf16_f32 v247, v228, v228
    v_cvt_pk_bf16_f32 v244, v242, v231
    s_mov_b32 exec_lo, 0
    ds_write_b128 v251, v[244:247] offset:3072
    s_mov_b32 exec_lo, -1
    s_waitcnt lgkmcnt(0)
    s_setprio 0
    s_barrier
    ds_read_b64 v[64:65], v16 offset:0
    ds_read_b64 v[66:67], v16 offset:8
    ds_read_b128 v[68:71], v17 offset:3072
    ds_read_b64 v[72:73], v16 offset:64
    ds_read_b64 v[74:75], v16 offset:72
    ds_read_b128 v[76:79], v17 offset:3136
    ds_read_b64 v[80:81], v16 offset:128
    ds_read_b64 v[82:83], v16 offset:136
    ds_read_b128 v[84:87], v17 offset:3200
    ds_read_b64 v[88:89], v16 offset:192
    ds_read_b64 v[90:91], v16 offset:200
    ds_read_b128 v[92:95], v17 offset:3264
    ds_read_b64 v[96:97], v16 offset:512
    ds_read_b64 v[98:99], v16 offset:520
    ds_read_b128 v[100:103], v17 offset:3584
    ds_read_b64 v[104:105], v16 offset:576
    ds_read_b64 v[106:107], v16 offset:584
    ds_read_b128 v[108:111], v17 offset:3648
    ds_read_b64 v[112:113], v16 offset:640
    ds_read_b64 v[114:115], v16 offset:648
    ds_read_b128 v[116:119], v17 offset:3712
    ds_read_b64 v[120:121], v16 offset:704
    ds_read_b64 v[122:123], v16 offset:712
    ds_read_b128 v[124:127], v17 offset:3776
    s_waitcnt lgkmcnt(15)
    v_mfma_f32_16x16x32_bf16 v[28:31], v[68:71], v[64:67], 0
    ds_read_b128 v[128:131], v17 offset:2048
    v_mfma_f32_16x16x32_bf16 v[28:31], v[76:79], v[72:75], v[28:31]
    ds_read_b128 v[132:135], v17 offset:2112
    v_mfma_f32_16x16x32_bf16 v[28:31], v[84:87], v[80:83], v[28:31]
    ds_read_b128 v[136:139], v17 offset:2176
    buffer_load_dwordx2 v[6:7], v2, s[4:7], 0 offen offset:896
    s_waitcnt lgkmcnt(15)
    v_mfma_f32_16x16x32_bf16 v[28:31], v[92:95], v[88:91], v[28:31]
    ds_read_b128 v[140:143], v17 offset:2240
    s_waitcnt lgkmcnt(13)
    v_mfma_f32_16x16x32_bf16 v[28:31], v[100:103], v[96:99], v[28:31]
    ds_read_b128 v[144:147], v17 offset:2560
    s_waitcnt lgkmcnt(11)
    v_mfma_f32_16x16x32_bf16 v[28:31], v[108:111], v[104:107], v[28:31]
    ds_read_b128 v[148:151], v17 offset:2624
    s_waitcnt lgkmcnt(9)
    v_mfma_f32_16x16x32_bf16 v[28:31], v[116:119], v[112:115], v[28:31]
    ds_read_b128 v[152:155], v17 offset:2688
    s_waitcnt lgkmcnt(7)
    v_mfma_f32_16x16x32_bf16 v[28:31], v[124:127], v[120:123], v[28:31]
    ds_read_b128 v[156:159], v17 offset:2752
    s_waitcnt lgkmcnt(7)
    v_mfma_f32_16x16x32_bf16 v[32:35], v[128:131], v[64:67], 0
    ds_read_b64 v[160:161], v16 offset:1024
    s_waitcnt lgkmcnt(7)
    v_mfma_f32_16x16x32_bf16 v[32:35], v[132:135], v[72:75], v[32:35]
    ds_read_b64 v[162:163], v16 offset:1032
    s_waitcnt lgkmcnt(7)
    v_mfma_f32_16x16x32_bf16 v[32:35], v[136:139], v[80:83], v[32:35]
    ds_read_b64 v[164:165], v16 offset:1088
    ds_read_b64 v[166:167], v16 offset:1096
    ds_write_addtid_b32 v28 offset:0
    s_waitcnt lgkmcnt(9)
    v_mfma_f32_16x16x32_bf16 v[32:35], v[140:143], v[88:91], v[32:35]
    ds_read_b64 v[168:169], v16 offset:1152
    ds_read_b64 v[170:171], v16 offset:1160
    ds_write_addtid_b32 v29 offset:8256
    s_waitcnt lgkmcnt(11)
    v_mfma_f32_16x16x32_bf16 v[32:35], v[144:147], v[96:99], v[32:35]
    ds_read_b64 v[172:173], v16 offset:1216
    ds_read_b64 v[174:175], v16 offset:1224
    ds_write_addtid_b32 v30 offset:16512
    s_waitcnt lgkmcnt(13)
    v_mfma_f32_16x16x32_bf16 v[32:35], v[148:151], v[104:107], v[32:35]
    ds_read_b64 v[176:177], v16 offset:1536
    ds_read_b64 v[178:179], v16 offset:1544
    ds_write_addtid_b32 v31 offset:24768
    s_waitcnt lgkmcnt(15)
    v_mfma_f32_16x16x32_bf16 v[32:35], v[152:155], v[112:115], v[32:35]
    ds_read_b64 v[180:181], v16 offset:1600
    ds_read_b64 v[182:183], v16 offset:1608
    s_waitcnt lgkmcnt(15)
    v_mfma_f32_16x16x32_bf16 v[32:35], v[156:159], v[120:123], v[32:35]
    ds_read_b64 v[184:185], v16 offset:1664
    ds_read_b64 v[186:187], v16 offset:1672
    s_waitcnt lgkmcnt(15)
    v_mfma_f32_16x16x32_bf16 v[32:35], v[68:71], v[160:163], v[32:35]
    ds_read_b64 v[188:189], v16 offset:1728
    ds_read_b64 v[190:191], v16 offset:1736
    s_waitcnt lgkmcnt(15)
    v_mfma_f32_16x16x32_bf16 v[32:35], v[76:79], v[164:167], v[32:35]
    ds_read_b128 v[192:195], v17 offset:1536
    s_waitcnt lgkmcnt(14)
    v_mfma_f32_16x16x32_bf16 v[32:35], v[84:87], v[168:171], v[32:35]
    ds_read_b128 v[196:199], v17 offset:1600
    s_waitcnt lgkmcnt(12)
    v_mfma_f32_16x16x32_bf16 v[32:35], v[92:95], v[172:175], v[32:35]
    ds_read_b128 v[200:203], v17 offset:1664
    s_waitcnt lgkmcnt(10)
    v_mfma_f32_16x16x32_bf16 v[32:35], v[100:103], v[176:179], v[32:35]
    ds_read_b128 v[204:207], v17 offset:1728
    s_waitcnt lgkmcnt(8)
    v_mfma_f32_16x16x32_bf16 v[32:35], v[108:111], v[180:183], v[32:35]
    ds_read_b128 v[208:211], v17 offset:1024
    s_waitcnt lgkmcnt(7)
    v_mfma_f32_16x16x32_bf16 v[32:35], v[116:119], v[184:187], v[32:35]
    ds_read_b128 v[212:215], v17 offset:1088
    s_waitcnt lgkmcnt(6)
    v_mfma_f32_16x16x32_bf16 v[32:35], v[124:127], v[188:191], v[32:35]
    ds_read_b128 v[216:219], v17 offset:1152
    s_waitcnt lgkmcnt(6)
    v_mfma_f32_16x16x32_bf16 v[36:39], v[192:195], v[64:67], 0
    ds_read_b128 v[220:223], v17 offset:1216
    s_waitcnt lgkmcnt(6)
    v_mfma_f32_16x16x32_bf16 v[36:39], v[196:199], v[72:75], v[36:39]
    s_waitcnt lgkmcnt(5)
    v_mfma_f32_16x16x32_bf16 v[36:39], v[200:203], v[80:83], v[36:39]
    ds_write_addtid_b32 v32 offset:2064
    s_waitcnt lgkmcnt(5)
    v_mfma_f32_16x16x32_bf16 v[36:39], v[204:207], v[88:91], v[36:39]
    ds_write_addtid_b32 v33 offset:10320
    v_mfma_f32_16x16x32_bf16 v[36:39], v[128:131], v[96:99], v[36:39]
    ds_write_addtid_b32 v34 offset:18576
    v_mfma_f32_16x16x32_bf16 v[36:39], v[132:135], v[104:107], v[36:39]
    ds_write_addtid_b32 v35 offset:26832
    v_mfma_f32_16x16x32_bf16 v[36:39], v[136:139], v[112:115], v[36:39]
    v_mfma_f32_16x16x32_bf16 v[36:39], v[140:143], v[120:123], v[36:39]
    v_bfe_u32 v46, v1, 3, 2
    v_mul_u32_u24 v46, 8256, v46
    v_and_b32 v47, 32, v1
    v_lshl_add_u32 v46, v47, 1, v46
    v_and_b32 v47, 7, v1
    v_lshl_add_u32 v46, v47, 3, v46
    s_lshr_b32 s3, s53, 1
    v_add_u32 v18, s3, v46
    s_add_u32 s3, s53, 64032
    v_lshl_add_u32 v19, v1, 2, s3
    v_mul_u32_u24 v47, 1792, v1
    s_mul_i32 s3, s53, 448
    s_add_u32 s3, s3, s14
    v_add_u32 v0, s3, v47
    s_mov_b32 s8, s30
    s_mov_b32 s9, s31
    s_mov_b32 s10, 1835008
    s_mov_b32 s11, 0x20000
    s_lshl_b32 s40, s38, 16
    s_and_b32 s41, s38, 0xffff0000
    s_lshl_b32 s42, s39, 16
    s_and_b32 s43, s39, 0xffff0000
    ds_read_b32 v21, v19 offset:512
    ds_read_b32 v23, v19 offset:17152
    ds_read_b32 v25, v19 offset:33792
    ds_read_b32 v27, v19 offset:50432
    s_waitcnt lgkmcnt(3)
    v_lshlrev_b32 v20, 16, v21
    v_and_b32 v21, 0xffff0000, v21
    v_mul_f32 v20, s40, v20
    v_mul_f32 v21, s40, v21
    v_cvt_pk_bf16_f32 v21, v20, v21
    v_lshlrev_b32 v20, 16, v21
    v_and_b32 v21, 0xffff0000, v21
    s_waitcnt lgkmcnt(2)
    v_lshlrev_b32 v22, 16, v23
    v_and_b32 v23, 0xffff0000, v23
    v_mul_f32 v22, s41, v22
    v_mul_f32 v23, s41, v23
    v_cvt_pk_bf16_f32 v23, v22, v23
    v_lshlrev_b32 v22, 16, v23
    v_and_b32 v23, 0xffff0000, v23
    s_waitcnt lgkmcnt(1)
    v_lshlrev_b32 v24, 16, v25
    v_and_b32 v25, 0xffff0000, v25
    v_mul_f32 v24, s42, v24
    v_mul_f32 v25, s42, v25
    v_cvt_pk_bf16_f32 v25, v24, v25
    v_lshlrev_b32 v24, 16, v25
    v_and_b32 v25, 0xffff0000, v25
    s_waitcnt lgkmcnt(0)
    v_lshlrev_b32 v26, 16, v27
    v_and_b32 v27, 0xffff0000, v27
    v_mul_f32 v26, s43, v26
    v_mul_f32 v27, s43, v27
    v_cvt_pk_bf16_f32 v27, v26, v27
    v_lshlrev_b32 v26, 16, v27
    v_and_b32 v27, 0xffff0000, v27
    s_setprio 2
    s_barrier
    s_waitcnt vmcnt(0)
    s_add_u32 s3, s47, 61000
    s_mov_b32 m0, s3
    v_mov_b32_dpp v14, v12 wave_ror:1 row_mask:0xf bank_mask:0xf
    v_mov_b32_dpp v15, v13 wave_ror:1 row_mask:0xf bank_mask:0xf
    v_mov_b32_dpp v12, v6 wave_shr:1 row_mask:0xf bank_mask:0xf
    v_mov_b32_dpp v13, v7 wave_shr:1 row_mask:0xf bank_mask:0xf
    v_perm_b32 v248, v6, v4, s44
    v_perm_b32 v249, v4, v12, s44
    v_perm_b32 v250, v6, v4, s45
    v_perm_b32 v251, v4, v12, s45
    v_perm_b32 v252, v7, v5, s44
    v_perm_b32 v253, v5, v13, s44
    v_perm_b32 v254, v7, v5, s45
    v_perm_b32 v255, v5, v13, s45
    ds_write_addtid_b32 v248 offset:3032
    ds_write_addtid_b32 v248 offset:11348
    ds_write_addtid_b32 v249 offset:15504
    ds_write_addtid_b32 v249 offset:7188
    ds_write_addtid_b32 v250 offset:19672
    ds_write_addtid_b32 v250 offset:27988
    ds_write_addtid_b32 v251 offset:32144
    ds_write_addtid_b32 v251 offset:23828
    ds_write_addtid_b32 v252 offset:36312
    ds_write_addtid_b32 v252 offset:44628
    ds_write_addtid_b32 v253 offset:48784
    ds_write_addtid_b32 v253 offset:40468
    ds_write_addtid_b32 v254 offset:52952
    ds_write_addtid_b32 v254 offset:61268
    ds_write_addtid_b32 v255 offset:65424
    ds_write_addtid_b32 v255 offset:57108
    s_mov_b32 m0, s46
    s_waitcnt lgkmcnt(0)
    s_barrier
    ds_read_b64 v[44:45], v18 offset:1024
    ds_read_b64 v[52:53], v18 offset:1536
    ds_read_b64 v[46:47], v18 offset:1280
    ds_read_b64 v[54:55], v18 offset:1792
    ds_read_b64 v[48:49], v18 offset:0
    ds_read_b64 v[56:57], v18 offset:512
    ds_read_b64 v[50:51], v18 offset:256
    ds_read_b64 v[58:59], v18 offset:768
    s_mov_b32 s55, 229376
    s_waitcnt lgkmcnt(6)
    v_add_f32 v44, v44, v52
    v_add_f32 v45, v45, v53
    v_cvt_pk_bf16_f32 v45, v44, v45
    v_lshlrev_b32 v44, 16, v45
    v_and_b32 v45, 0xffff0000, v45
    v_add_f32 v44, v44, v20
    v_add_f32 v45, v45, v21
    s_waitcnt lgkmcnt(4)
    v_add_f32 v46, v46, v54
    v_add_f32 v47, v47, v55
    v_cvt_pk_bf16_f32 v47, v46, v47
    v_lshlrev_b32 v46, 16, v47
    v_and_b32 v47, 0xffff0000, v47
    v_add_f32 v46, v46, v22
    v_add_f32 v47, v47, v23
    s_waitcnt lgkmcnt(2)
    v_add_f32 v48, v48, v56
    v_add_f32 v49, v49, v57
    v_cvt_pk_bf16_f32 v49, v48, v49
    v_lshlrev_b32 v48, 16, v49
    v_and_b32 v49, 0xffff0000, v49
    v_add_f32 v48, v48, v24
    v_add_f32 v49, v49, v25
    s_waitcnt lgkmcnt(0)
    v_add_f32 v50, v50, v58
    v_add_f32 v51, v51, v59
    v_cvt_pk_bf16_f32 v51, v50, v51
    v_lshlrev_b32 v50, 16, v51
    v_and_b32 v51, 0xffff0000, v51
    v_add_f32 v50, v50, v26
    v_add_f32 v51, v51, v27
    v_cvt_pk_bf16_f32 v52, v44, v46
    v_cvt_pk_bf16_f32 v53, v48, v50
    buffer_store_dwordx2 v[52:53], v0, s[8:11], s55 offen offset:0
    v_cvt_pk_bf16_f32 v54, v45, v47
    v_cvt_pk_bf16_f32 v55, v49, v51
    buffer_store_dwordx2 v[54:55], v0, s[8:11], s55 offen offset:896
    v_mfma_f32_16x16x32_bf16 v[36:39], v[144:147], v[160:163], v[36:39]
    ds_read_b64 v[224:225], v16 offset:2048
    v_mfma_f32_16x16x32_bf16 v[36:39], v[148:151], v[164:167], v[36:39]
    ds_read_b64 v[226:227], v16 offset:2056
    v_mfma_f32_16x16x32_bf16 v[36:39], v[152:155], v[168:171], v[36:39]
    ds_read_b64 v[228:229], v16 offset:2112
    v_mfma_f32_16x16x32_bf16 v[36:39], v[156:159], v[172:175], v[36:39]
    ds_read_b64 v[230:231], v16 offset:2120
    v_mfma_f32_16x16x32_bf16 v[36:39], v[68:71], v[176:179], v[36:39]
    ds_read_b64 v[232:233], v16 offset:2176
    v_mfma_f32_16x16x32_bf16 v[36:39], v[76:79], v[180:183], v[36:39]
    ds_read_b64 v[234:235], v16 offset:2184
    v_mfma_f32_16x16x32_bf16 v[36:39], v[84:87], v[184:187], v[36:39]
    ds_read_b64 v[236:237], v16 offset:2240
    v_mfma_f32_16x16x32_bf16 v[36:39], v[92:95], v[188:191], v[36:39]
    ds_read_b64 v[238:239], v16 offset:2248
    ds_read_b32 v21, v19 offset:2048
    ds_read_b32 v23, v19 offset:18688
    ds_read_b32 v25, v19 offset:35328
    ds_read_b32 v27, v19 offset:51968
    s_waitcnt lgkmcnt(3)
    v_lshlrev_b32 v20, 16, v21
    v_and_b32 v21, 0xffff0000, v21
    v_mul_f32 v20, s40, v20
    v_mul_f32 v21, s40, v21
    v_cvt_pk_bf16_f32 v21, v20, v21
    v_lshlrev_b32 v20, 16, v21
    v_and_b32 v21, 0xffff0000, v21
    s_waitcnt lgkmcnt(2)
    v_lshlrev_b32 v22, 16, v23
    v_and_b32 v23, 0xffff0000, v23
    s_barrier
    v_mfma_f32_16x16x32_bf16 v[40:43], v[208:211], v[64:67], 0
    ds_read_b64 v[240:241], v16 offset:2560
    v_mfma_f32_16x16x32_bf16 v[40:43], v[212:215], v[72:75], v[40:43]
    ds_read_b64 v[242:243], v16 offset:2568
    v_mfma_f32_16x16x32_bf16 v[40:43], v[216:219], v[80:83], v[40:43]
    ds_read_b64 v[244:245], v16 offset:2624
    v_mfma_f32_16x16x32_bf16 v[40:43], v[220:223], v[88:91], v[40:43]
    ds_read_b64 v[246:247], v16 offset:2632
    v_mfma_f32_16x16x32_bf16 v[40:43], v[192:195], v[96:99], v[40:43]
    ds_read_b64 v[64:65], v16 offset:2688
    v_mfma_f32_16x16x32_bf16 v[40:43], v[196:199], v[104:107], v[40:43]
    ds_read_b64 v[66:67], v16 offset:2696
    v_mfma_f32_16x16x32_bf16 v[40:43], v[200:203], v[112:115], v[40:43]
    ds_read_b64 v[208:209], v16 offset:2752
    v_mfma_f32_16x16x32_bf16 v[40:43], v[204:207], v[120:123], v[40:43]
    ds_read_b64 v[210:211], v16 offset:2760
    v_mfma_f32_16x16x32_bf16 v[40:43], v[128:131], v[160:163], v[40:43]
    v_mfma_f32_16x16x32_bf16 v[40:43], v[132:135], v[164:167], v[40:43]
    v_mfma_f32_16x16x32_bf16 v[40:43], v[136:139], v[168:171], v[40:43]
    v_mfma_f32_16x16x32_bf16 v[40:43], v[140:143], v[172:175], v[40:43]
    v_mfma_f32_16x16x32_bf16 v[40:43], v[144:147], v[176:179], v[40:43]
    v_mfma_f32_16x16x32_bf16 v[40:43], v[148:151], v[180:183], v[40:43]
    v_mfma_f32_16x16x32_bf16 v[40:43], v[152:155], v[184:187], v[40:43]
    v_mfma_f32_16x16x32_bf16 v[40:43], v[156:159], v[188:191], v[40:43]
    v_mfma_f32_16x16x32_bf16 v[36:39], v[100:103], v[224:227], v[36:39]
    v_mfma_f32_16x16x32_bf16 v[36:39], v[108:111], v[228:231], v[36:39]
    v_mfma_f32_16x16x32_bf16 v[36:39], v[116:119], v[232:235], v[36:39]
    v_mfma_f32_16x16x32_bf16 v[36:39], v[124:127], v[236:239], v[36:39]
    s_nop 7
    ds_write_addtid_b32 v36 offset:4128
    ds_write_addtid_b32 v37 offset:12384
    ds_write_addtid_b32 v38 offset:20640
    ds_write_addtid_b32 v39 offset:28896
    v_mul_f32 v22, s41, v22
    v_mul_f32 v23, s41, v23
    v_cvt_pk_bf16_f32 v23, v22, v23
    v_lshlrev_b32 v22, 16, v23
    v_and_b32 v23, 0xffff0000, v23
    s_waitcnt lgkmcnt(13)
    v_lshlrev_b32 v24, 16, v25
    v_and_b32 v25, 0xffff0000, v25
    v_mul_f32 v24, s42, v24
    v_mul_f32 v25, s42, v25
    v_cvt_pk_bf16_f32 v25, v24, v25
    v_lshlrev_b32 v24, 16, v25
    v_and_b32 v25, 0xffff0000, v25
    s_waitcnt lgkmcnt(12)
    v_lshlrev_b32 v26, 16, v27
    v_and_b32 v27, 0xffff0000, v27
    v_mul_f32 v26, s43, v26
    v_mul_f32 v27, s43, v27
    v_cvt_pk_bf16_f32 v27, v26, v27
    v_lshlrev_b32 v26, 16, v27
    v_and_b32 v27, 0xffff0000, v27
    s_waitcnt lgkmcnt(0)
    s_barrier
    ds_read_b64 v[44:45], v18 offset:5152
    ds_read_b64 v[52:53], v18 offset:5664
    ds_read_b64 v[46:47], v18 offset:5408
    ds_read_b64 v[54:55], v18 offset:5920
    ds_read_b64 v[48:49], v18 offset:4128
    ds_read_b64 v[56:57], v18 offset:4640
    ds_read_b64 v[50:51], v18 offset:4384
    ds_read_b64 v[58:59], v18 offset:4896
    s_mov_b32 s55, 917504
    s_waitcnt lgkmcnt(6)
    v_add_f32 v44, v44, v52
    v_add_f32 v45, v45, v53
    v_cvt_pk_bf16_f32 v45, v44, v45
    v_lshlrev_b32 v44, 16, v45
    v_and_b32 v45, 0xffff0000, v45
    v_add_f32 v44, v44, v20
    v_add_f32 v45, v45, v21
    s_waitcnt lgkmcnt(4)
    v_add_f32 v46, v46, v54
    v_add_f32 v47, v47, v55
    v_cvt_pk_bf16_f32 v47, v46, v47
    v_lshlrev_b32 v46, 16, v47
    v_and_b32 v47, 0xffff0000, v47
    v_add_f32 v46, v46, v22
    v_add_f32 v47, v47, v23
    s_waitcnt lgkmcnt(2)
    v_add_f32 v48, v48, v56
    v_add_f32 v49, v49, v57
    v_cvt_pk_bf16_f32 v49, v48, v49
    v_lshlrev_b32 v48, 16, v49
    v_and_b32 v49, 0xffff0000, v49
    v_add_f32 v48, v48, v24
    v_add_f32 v49, v49, v25
    s_waitcnt lgkmcnt(0)
    v_add_f32 v50, v50, v58
    v_add_f32 v51, v51, v59
    v_cvt_pk_bf16_f32 v51, v50, v51
    v_lshlrev_b32 v50, 16, v51
    v_and_b32 v51, 0xffff0000, v51
    v_add_f32 v50, v50, v26
    v_add_f32 v51, v51, v27
    v_cvt_pk_bf16_f32 v52, v44, v46
    v_cvt_pk_bf16_f32 v53, v48, v50
    buffer_store_dwordx2 v[52:53], v0, s[8:11], s55 offen offset:0
    v_cvt_pk_bf16_f32 v54, v45, v47
    v_cvt_pk_bf16_f32 v55, v49, v51
    buffer_store_dwordx2 v[54:55], v0, s[8:11], s55 offen offset:896
    v_mfma_f32_16x16x32_bf16 v[40:43], v[68:71], v[224:227], v[40:43]
    v_mfma_f32_16x16x32_bf16 v[40:43], v[76:79], v[228:231], v[40:43]
    v_mfma_f32_16x16x32_bf16 v[40:43], v[84:87], v[232:235], v[40:43]
    v_mfma_f32_16x16x32_bf16 v[40:43], v[92:95], v[236:239], v[40:43]
    v_mfma_f32_16x16x32_bf16 v[40:43], v[100:103], v[240:243], v[40:43]
    v_mfma_f32_16x16x32_bf16 v[40:43], v[108:111], v[244:247], v[40:43]
    v_mfma_f32_16x16x32_bf16 v[40:43], v[116:119], v[64:67], v[40:43]
    v_mfma_f32_16x16x32_bf16 v[40:43], v[124:127], v[208:211], v[40:43]
    s_nop 7
    ds_write_addtid_b32 v40 offset:6192
    ds_write_addtid_b32 v41 offset:14448
    ds_write_addtid_b32 v42 offset:22704
    ds_write_addtid_b32 v43 offset:30960
    s_waitcnt lgkmcnt(0)
    s_barrier
    s_endpgm
.p2align 6
L_t5:
    s_branch L_tback
    s_nop 0
L_cv5:
    s_setprio 0
    s_mul_i32 s48, s33, 4608
    s_add_u32 s48, s48, 130560
    v_and_b32 v46, 31, v1
    v_lshrrev_b32 v47, 5, v1
    v_lshlrev_b32 v250, 4, v46
    s_waitcnt lgkmcnt(7)
    v_mfma_f32_32x32x16_f16 v[224:239], v[192:195], v[128:131], 0
    v_lshl_add_u32 v250, v47, 3, v250
    s_add_u32 s3, s48, 4088
    v_sub_u32 v250, s3, v250
    v_lshlrev_b32 v251, 4, v1
    s_xor_b32 s3, s15, s34
    s_waitcnt lgkmcnt(6)
    v_mfma_f32_32x32x16_f16 v[224:239], v[196:199], v[132:135], v[224:239]
    s_lshl_b32 s3, s3, 2
    s_and_b32 s57, s32, 3
    s_add_u32 s3, s3, s57
    s_lshl_b32 s3, s3, 11
    s_add_u32 s3, s3, s96
    s_waitcnt lgkmcnt(5)
    v_mfma_f32_32x32x16_f16 v[224:239], v[200:203], v[136:139], v[224:239]
    s_sub_u32 s3, s3, 32768
    v_add_u32 v249, s3, v251
    s_add_u32 s3, s48, 1008
    v_sub_u32 v251, s3, v251
    v_and_b32 v46, 15, v1
    s_waitcnt lgkmcnt(4)
    v_mfma_f32_32x32x16_f16 v[224:239], v[204:207], v[140:143], v[224:239]
    v_and_b32 v47, 48, v1
    v_add_u32 v48, 1, v46
    v_and_b32 v49, 3, v48
    v_and_b32 v48, 28, v48
    v_mul_u32_u24 v49, 4160, v49
    s_waitcnt lgkmcnt(3)
    v_mfma_f32_32x32x16_f16 v[224:239], v[208:211], v[144:147], v[224:239]
    v_lshl_add_u32 v48, v48, 1, v47
    s_and_b32 s57, s32, 2
    s_lshl_b32 s57, s57, 7
    s_mul_i32 s3, s33, 16640
    s_add_u32 s3, s3, s57
    s_waitcnt lgkmcnt(2)
    v_mfma_f32_32x32x16_f16 v[224:239], v[212:215], v[148:151], v[224:239]
    s_add_u32 s3, s3, 64000
    v_add3_u32 v16, v48, v49, s3
    s_add_u32 s3, s48, s57
    s_add_u32 s3, s3, 480
    v_lshlrev_b32 v48, 5, v46
    s_waitcnt lgkmcnt(1)
    v_mfma_f32_32x32x16_f16 v[224:239], v[216:219], v[152:155], v[224:239]
    v_add_u32 v49, s3, v47
    v_sub_u32 v17, v49, v48
    s_mov_b32 s44, 0x05040100
    s_mov_b32 s45, 0x07060302
    s_waitcnt lgkmcnt(0)
    v_mfma_f32_32x32x16_f16 v[224:239], v[220:223], v[156:159], v[224:239]
    s_waitcnt vmcnt(1)
    v_readfirstlane_b32 s3, v248
    s_nop 1
    s_mul_i32 s3, s3, 0x9e3779b1
    s_add_u32 s3, s3, 0x7f4a7c15
    s_getreg_b32 s97, hwreg(HW_REG_XCC_ID)
    s_and_b32 s97, s97, 7
    s_add_u32 s97, s97, 1
    s_xor_b32 s97, s97, s3
    s_mov_b32 s99, s3
    v_mov_b32 v60, s97
    v_mul_f32 v224, v224, v43
    ds_write_addtid_b32 v224 offset:0
    v_mul_f32 v225, v225, v43
    ds_write_addtid_b32 v225 offset:2064
    v_mul_f32 v226, v226, v43
    ds_write_addtid_b32 v226 offset:4128
    v_mul_f32 v227, v227, v43
    ds_write_addtid_b32 v227 offset:6192
    v_mul_f32 v228, v228, v43
    ds_write_addtid_b32 v228 offset:8256
    v_mul_f32 v229, v229, v43
    ds_write_addtid_b32 v229 offset:10320
    v_mul_f32 v230, v230, v43
    ds_write_addtid_b32 v230 offset:12384
    v_mul_f32 v231, v231, v43
    ds_write_addtid_b32 v231 offset:14448
    s_mov_b32 m0, s53
    s_waitcnt lgkmcnt(0)
    s_setprio 2
    s_barrier
    ds_read_addtid_b32 v160 offset:16512
    ds_read_addtid_b32 v161 offset:18576
    ds_read_addtid_b32 v162 offset:20640
    ds_read_addtid_b32 v163 offset:22704
    ds_read_addtid_b32 v164 offset:24768
    ds_read_addtid_b32 v168 offset:17536
    ds_read_addtid_b32 v169 offset:19600
    ds_read_addtid_b32 v170 offset:21664
    ds_read_addtid_b32 v171 offset:23728
    ds_read_addtid_b32 v172 offset:25792
    ds_read_addtid_b32 v176 offset:18048
    ds_read_addtid_b32 v177 offset:20112
    ds_read_addtid_b32 v178 offset:22176
    ds_read_addtid_b32 v179 offset:24240
    ds_read_addtid_b32 v180 offset:26304
    s_mov_b32 m0, s46
    v_mov_b32 v187, v60
    v_mov_b32 v189, v60
    s_waitcnt lgkmcnt(10)
    v_fma_f32 v232, v232, v43, v160
    v_fma_f32 v233, v233, v43, v161
    v_fma_f32 v234, v234, v43, v162
    v_fma_f32 v235, v235, v43, v163
    v_fma_f32 v236, v236, v43, v164
    s_waitcnt lgkmcnt(5)
    v_add_f32 v232, v232, v168
    v_add_f32 v233, v233, v169
    v_add_f32 v234, v234, v170
    v_add_f32 v235, v235, v171
    v_add_f32 v236, v236, v172
    s_waitcnt lgkmcnt(0)
    v_add_f32 v232, v232, v176
    v_add_f32 v233, v233, v177
    v_add_f32 v234, v234, v178
    v_add_f32 v235, v235, v179
    v_add_f32 v236, v236, v180
    v_cvt_pk_bf16_f32 v184, v232, v233
    v_cvt_pk_bf16_f32 v185, v234, v235
    v_cvt_pk_bf16_f32 v186, v236, v236
    global_store_dwordx4 v249, v[184:187], s[62:63]
    s_mov_b32 vcc_lo, 0xaaaaaaaa
    s_mov_b32 vcc_hi, 0xaaaaaaaa
    v_mov_b32_dpp v240, v234 wave_rol:1 row_mask:0xf bank_mask:0xf
    v_cvt_pk_bf16_f32 v225, v233, v233
    v_cvt_pk_bf16_f32 v226, v233, v232
    v_mov_b32_dpp v240, v232 wave_shl:1 row_mask:0xf bank_mask:0xf
    v_cvt_pk_bf16_f32 v227, v232, v232
    v_mov_b32_dpp v241, v235 wave_rol:1 row_mask:0xf bank_mask:0xf
    v_cvt_pk_bf16_f32 v224, v240, v240
    v_mov_b32_dpp v242, v236 wave_rol:1 row_mask:0xf bank_mask:0xf
    ds_write_b128 v251, v[224:227] offset:2048
    v_mov_b32_dpp v241, v234 wave_shl:1 row_mask:0xf bank_mask:0xf
    v_mov_b32_dpp v242, v235 wave_shl:1 row_mask:0xf bank_mask:0xf
    v_cndmask_b32 v243, v234, v241, vcc
    v_cvt_pk_bf16_f32 v230, v234, v234
    v_cvt_pk_bf16_f32 v231, v234, v234
    v_cvt_pk_bf16_f32 v228, v241, v241
    v_cvt_pk_bf16_f32 v229, v241, v243
    ds_write_b128 v251, v[228:231] offset:1024
    v_cndmask_b32 v243, v235, v242, vcc
    v_cvt_pk_bf16_f32 v246, v235, v235
    v_cvt_pk_bf16_f32 v247, v235, v235
    v_cvt_pk_bf16_f32 v244, v242, v242
    v_cvt_pk_bf16_f32 v245, v242, v243
    ds_write_b128 v251, v[244:247] offset:0
    s_waitcnt lgkmcnt(0)
    s_setprio 0
    s_barrier
    ds_read_b64 v[64:65], v16 offset:0
    ds_read_b64 v[66:67], v16 offset:8
    ds_read_b128 v[68:71], v17 offset:3072
    ds_read_b64 v[72:73], v16 offset:64
    ds_read_b64 v[74:75], v16 offset:72
    ds_read_b128 v[76:79], v17 offset:3136
    ds_read_b64 v[80:81], v16 offset:128
    ds_read_b64 v[82:83], v16 offset:136
    ds_read_b128 v[84:87], v17 offset:3200
    ds_read_b64 v[88:89], v16 offset:192
    ds_read_b64 v[90:91], v16 offset:200
    ds_read_b128 v[92:95], v17 offset:3264
    ds_read_b64 v[96:97], v16 offset:512
    ds_read_b64 v[98:99], v16 offset:520
    ds_read_b128 v[100:103], v17 offset:3584
    ds_read_b64 v[104:105], v16 offset:576
    ds_read_b64 v[106:107], v16 offset:584
    ds_read_b128 v[108:111], v17 offset:3648
    ds_read_b64 v[112:113], v16 offset:640
    ds_read_b64 v[114:115], v16 offset:648
    ds_read_b128 v[116:119], v17 offset:3712
    ds_read_b64 v[120:121], v16 offset:704
    ds_read_b64 v[122:123], v16 offset:712
    ds_read_b128 v[124:127], v17 offset:3776
    s_waitcnt lgkmcnt(15)
    v_mfma_f32_16x16x32_bf16 v[28:31], v[68:71], v[64:67], 0
    ds_read_b128 v[128:131], v17 offset:2048
    v_mfma_f32_16x16x32_bf16 v[28:31], v[76:79], v[72:75], v[28:31]
    ds_read_b128 v[132:135], v17 offset:2112
    v_mfma_f32_16x16x32_bf16 v[28:31], v[84:87], v[80:83], v[28:31]
    ds_read_b128 v[136:139], v17 offset:2176
    buffer_load_dwordx2 v[4:5], v2, s[4:7], 0 offen offset:0
    s_waitcnt lgkmcnt(15)
    v_mfma_f32_16x16x32_bf16 v[28:31], v[92:95], v[88:91], v[28:31]
    ds_read_b128 v[140:143], v17 offset:2240
    s_waitcnt lgkmcnt(13)
    v_mfma_f32_16x16x32_bf16 v[28:31], v[100:103], v[96:99], v[28:31]
    ds_read_b128 v[144:147], v17 offset:2560
    s_waitcnt lgkmcnt(11)
    v_mfma_f32_16x16x32_bf16 v[28:31], v[108:111], v[104:107], v[28:31]
    ds_read_b128 v[148:151], v17 offset:2624
    s_waitcnt lgkmcnt(9)
    v_mfma_f32_16x16x32_bf16 v[28:31], v[116:119], v[112:115], v[28:31]
    ds_read_b128 v[152:155], v17 offset:2688
    s_waitcnt lgkmcnt(7)
    v_mfma_f32_16x16x32_bf16 v[28:31], v[124:127], v[120:123], v[28:31]
    ds_read_b128 v[156:159], v17 offset:2752
    s_waitcnt lgkmcnt(7)
    v_mfma_f32_16x16x32_bf16 v[32:35], v[128:131], v[64:67], 0
    ds_read_b64 v[160:161], v16 offset:1024
    s_waitcnt lgkmcnt(7)
    v_mfma_f32_16x16x32_bf16 v[32:35], v[132:135], v[72:75], v[32:35]
    ds_read_b64 v[162:163], v16 offset:1032
    s_waitcnt lgkmcnt(7)
    v_mfma_f32_16x16x32_bf16 v[32:35], v[136:139], v[80:83], v[32:35]
    ds_read_b64 v[164:165], v16 offset:1088
    ds_read_b64 v[166:167], v16 offset:1096
    ds_write_addtid_b32 v28 offset:0
    s_waitcnt lgkmcnt(9)
    v_mfma_f32_16x16x32_bf16 v[32:35], v[140:143], v[88:91], v[32:35]
    ds_read_b64 v[168:169], v16 offset:1152
    ds_read_b64 v[170:171], v16 offset:1160
    ds_write_addtid_b32 v29 offset:8256
    buffer_load_dwordx2 v[6:7], v2, s[4:7], 0 offen offset:896
    s_waitcnt lgkmcnt(11)
    v_mfma_f32_16x16x32_bf16 v[32:35], v[144:147], v[96:99], v[32:35]
    ds_read_b64 v[172:173], v16 offset:1216
    ds_read_b64 v[174:175], v16 offset:1224
    ds_write_addtid_b32 v30 offset:16512
    s_waitcnt lgkmcnt(13)
    v_mfma_f32_16x16x32_bf16 v[32:35], v[148:151], v[104:107], v[32:35]
    ds_read_b64 v[176:177], v16 offset:1536
    ds_read_b64 v[178:179], v16 offset:1544
    ds_write_addtid_b32 v31 offset:24768
    s_waitcnt lgkmcnt(15)
    v_mfma_f32_16x16x32_bf16 v[32:35], v[152:155], v[112:115], v[32:35]
    ds_read_b64 v[180:181], v16 offset:1600
    ds_read_b64 v[182:183], v16 offset:1608
    s_waitcnt lgkmcnt(15)
    v_mfma_f32_16x16x32_bf16 v[32:35], v[156:159], v[120:123], v[32:35]
    ds_read_b64 v[184:185], v16 offset:1664
    ds_read_b64 v[186:187], v16 offset:1672
    s_waitcnt lgkmcnt(15)
    v_mfma_f32_16x16x32_bf16 v[32:35], v[68:71], v[160:163], v[32:35]
    ds_read_b64 v[188:189], v16 offset:1728
    ds_read_b64 v[190:191], v16 offset:1736
    s_waitcnt lgkmcnt(15)
    v_mfma_f32_16x16x32_bf16 v[32:35], v[76:79], v[164:167], v[32:35]
    ds_read_b128 v[192:195], v17 offset:1536
    s_waitcnt lgkmcnt(14)
    v_mfma_f32_16x16x32_bf16 v[32:35], v[84:87], v[168:171], v[32:35]
    ds_read_b128 v[196:199], v17 offset:1600
    s_waitcnt lgkmcnt(12)
    v_mfma_f32_16x16x32_bf16 v[32:35], v[92:95], v[172:175], v[32:35]
    ds_read_b128 v[200:203], v17 offset:1664
    s_waitcnt lgkmcnt(10)
    v_mfma_f32_16x16x32_bf16 v[32:35], v[100:103], v[176:179], v[32:35]
    ds_read_b128 v[204:207], v17 offset:1728
    s_waitcnt lgkmcnt(8)
    v_mfma_f32_16x16x32_bf16 v[32:35], v[108:111], v[180:183], v[32:35]
    ds_read_b128 v[208:211], v17 offset:1024
    s_waitcnt lgkmcnt(7)
    v_mfma_f32_16x16x32_bf16 v[32:35], v[116:119], v[184:187], v[32:35]
    ds_read_b128 v[212:215], v17 offset:1088
    s_waitcnt lgkmcnt(6)
    v_mfma_f32_16x16x32_bf16 v[32:35], v[124:127], v[188:191], v[32:35]
    ds_read_b128 v[216:219], v17 offset:1152
    s_waitcnt lgkmcnt(6)
    v_mfma_f32_16x16x32_bf16 v[36:39], v[192:195], v[64:67], 0
    ds_read_b128 v[220:223], v17 offset:1216
    s_waitcnt lgkmcnt(6)
    v_mfma_f32_16x16x32_bf16 v[36:39], v[196:199], v[72:75], v[36:39]
    s_waitcnt lgkmcnt(5)
    v_mfma_f32_16x16x32_bf16 v[36:39], v[200:203], v[80:83], v[36:39]
    ds_write_addtid_b32 v32 offset:2064
    s_waitcnt lgkmcnt(5)
    v_mfma_f32_16x16x32_bf16 v[36:39], v[204:207], v[88:91], v[36:39]
    ds_write_addtid_b32 v33 offset:10320
    v_mfma_f32_16x16x32_bf16 v[36:39], v[128:131], v[96:99], v[36:39]
    ds_write_addtid_b32 v34 offset:18576
    v_mfma_f32_16x16x32_bf16 v[36:39], v[132:135], v[104:107], v[36:39]
    ds_write_addtid_b32 v35 offset:26832
    v_mfma_f32_16x16x32_bf16 v[36:39], v[136:139], v[112:115], v[36:39]
    v_mfma_f32_16x16x32_bf16 v[36:39], v[140:143], v[120:123], v[36:39]
    v_bfe_u32 v46, v1, 3, 2
    v_mul_u32_u24 v46, 8256, v46
    v_and_b32 v47, 32, v1
    v_lshl_add_u32 v46, v47, 1, v46
    v_and_b32 v47, 7, v1
    v_lshl_add_u32 v46, v47, 3, v46
    s_lshr_b32 s3, s53, 1
    v_add_u32 v18, s3, v46
    s_add_u32 s3, s53, 64032
    v_lshl_add_u32 v19, v1, 2, s3
    v_mul_u32_u24 v47, 1792, v1
    s_mul_i32 s3, s53, 448
    s_add_u32 s3, s3, s14
    v_add_u32 v0, s3, v47
    s_mov_b32 s8, s30
    s_mov_b32 s9, s31
    s_mov_b32 s10, 1835008
    s_mov_b32 s11, 0x20000
    s_lshl_b32 s40, s38, 16
    s_and_b32 s41, s38, 0xffff0000
    s_lshl_b32 s42, s39, 16
    s_and_b32 s43, s39, 0xffff0000
    ds_read_b32 v21, v19 offset:1536
    ds_read_b32 v23, v19 offset:18176
    ds_read_b32 v25, v19 offset:34816
    ds_read_b32 v27, v19 offset:51456
    s_waitcnt lgkmcnt(3)
    v_lshlrev_b32 v20, 16, v21
    v_and_b32 v21, 0xffff0000, v21
    v_mul_f32 v20, s40, v20
    v_mul_f32 v21, s40, v21
    v_cvt_pk_bf16_f32 v21, v20, v21
    v_lshlrev_b32 v20, 16, v21
    v_and_b32 v21, 0xffff0000, v21
    s_waitcnt lgkmcnt(2)
    v_lshlrev_b32 v22, 16, v23
    v_and_b32 v23, 0xffff0000, v23
    v_mul_f32 v22, s41, v22
    v_mul_f32 v23, s41, v23
    v_cvt_pk_bf16_f32 v23, v22, v23
    v_lshlrev_b32 v22, 16, v23
    v_and_b32 v23, 0xffff0000, v23
    s_waitcnt lgkmcnt(1)
    v_lshlrev_b32 v24, 16, v25
    v_and_b32 v25, 0xffff0000, v25
    v_mul_f32 v24, s42, v24
    v_mul_f32 v25, s42, v25
    v_cvt_pk_bf16_f32 v25, v24, v25
    v_lshlrev_b32 v24, 16, v25
    v_and_b32 v25, 0xffff0000, v25
    s_waitcnt lgkmcnt(0)
    v_lshlrev_b32 v26, 16, v27
    v_and_b32 v27, 0xffff0000, v27
    v_mul_f32 v26, s43, v26
    v_mul_f32 v27, s43, v27
    v_cvt_pk_bf16_f32 v27, v26, v27
    v_lshlrev_b32 v26, 16, v27
    v_and_b32 v27, 0xffff0000, v27
    s_setprio 2
    s_barrier
    s_waitcnt vmcnt(0)
    s_add_u32 s3, s47, 61000
    s_mov_b32 m0, s3
    v_mov_b32_dpp v14, v12 wave_ror:1 row_mask:0xf bank_mask:0xf
    v_mov_b32_dpp v15, v13 wave_ror:1 row_mask:0xf bank_mask:0xf
    v_mov_b32_dpp v12, v6 wave_shr:1 row_mask:0xf bank_mask:0xf
    v_mov_b32_dpp v13, v7 wave_shr:1 row_mask:0xf bank_mask:0xf
    v_perm_b32 v248, v6, v4, s44
    v_perm_b32 v249, v4, v12, s44
    v_perm_b32 v250, v6, v4, s45
    v_perm_b32 v251, v4, v12, s45
    v_perm_b32 v252, v7, v5, s44
    v_perm_b32 v253, v5, v13, s44
    v_perm_b32 v254, v7, v5, s45
    v_perm_b32 v255, v5, v13, s45
    ds_write_addtid_b32 v248 offset:3032
    ds_write_addtid_b32 v248 offset:11348
    ds_write_addtid_b32 v249 offset:15504
    ds_write_addtid_b32 v249 offset:7188
    ds_write_addtid_b32 v250 offset:19672
    ds_write_addtid_b32 v250 offset:27988
    ds_write_addtid_b32 v251 offset:32144
    ds_write_addtid_b32 v251 offset:23828
    ds_write_addtid_b32 v252 offset:36312
    ds_write_addtid_b32 v252 offset:44628
    ds_write_addtid_b32 v253 offset:48784
    ds_write_addtid_b32 v253 offset:40468
    ds_write_addtid_b32 v254 offset:52952
    ds_write_addtid_b32 v254 offset:61268
    ds_write_addtid_b32 v255 offset:65424
    ds_write_addtid_b32 v255 offset:57108
    s_mov_b32 m0, s46
    s_waitcnt lgkmcnt(0)
    s_barrier
    v_mfma_f32_16x16x32_bf16 v[36:39], v[144:147], v[160:163], v[36:39]
    ds_read_b64 v[224:225], v16 offset:2048
    v_mfma_f32_16x16x32_bf16 v[36:39], v[148:151], v[164:167], v[36:39]
    ds_read_b64 v[226:227], v16 offset:2056
    v_mfma_f32_16x16x32_bf16 v[36:39], v[152:155], v[168:171], v[36:39]
    ds_read_b64 v[228:229], v16 offset:2112
    v_mfma_f32_16x16x32_bf16 v[36:39], v[156:159], v[172:175], v[36:39]
    ds_read_b64 v[230:231], v16 offset:2120
    v_mfma_f32_16x16x32_bf16 v[36:39], v[68:71], v[176:179], v[36:39]
    ds_read_b64 v[232:233], v16 offset:2176
    v_mfma_f32_16x16x32_bf16 v[36:39], v[76:79], v[180:183], v[36:39]
    ds_read_b64 v[234:235], v16 offset:2184
    v_mfma_f32_16x16x32_bf16 v[36:39], v[84:87], v[184:187], v[36:39]
    ds_read_b64 v[236:237], v16 offset:2240
    v_mfma_f32_16x16x32_bf16 v[36:39], v[92:95], v[188:191], v[36:39]
    ds_read_b64 v[238:239], v16 offset:2248
    s_waitcnt lgkmcnt(0)
    s_barrier
    ds_read_b64 v[44:45], v18 offset:3088
    ds_read_b64 v[52:53], v18 offset:3600
    ds_read_b64 v[46:47], v18 offset:3344
    ds_read_b64 v[54:55], v18 offset:3856
    ds_read_b64 v[48:49], v18 offset:2064
    ds_read_b64 v[56:57], v18 offset:2576
    ds_read_b64 v[50:51], v18 offset:2320
    ds_read_b64 v[58:59], v18 offset:2832
    s_mov_b32 s55, 688128
    s_waitcnt lgkmcnt(6)
    v_add_f32 v44, v44, v52
    v_add_f32 v45, v45, v53
    v_cvt_pk_bf16_f32 v45, v44, v45
    v_lshlrev_b32 v44, 16, v45
    v_and_b32 v45, 0xffff0000, v45
    v_add_f32 v44, v44, v20
    v_add_f32 v45, v45, v21
    s_waitcnt lgkmcnt(4)
    v_add_f32 v46, v46, v54
    v_add_f32 v47, v47, v55
    v_cvt_pk_bf16_f32 v47, v46, v47
    v_lshlrev_b32 v46, 16, v47
    v_and_b32 v47, 0xffff0000, v47
    v_add_f32 v46, v46, v22
    v_add_f32 v47, v47, v23
    s_waitcnt lgkmcnt(2)
    v_add_f32 v48, v48, v56
    v_add_f32 v49, v49, v57
    v_cvt_pk_bf16_f32 v49, v48, v49
    v_lshlrev_b32 v48, 16, v49
    v_and_b32 v49, 0xffff0000, v49
    v_add_f32 v48, v48, v24
    v_add_f32 v49, v49, v25
    s_waitcnt lgkmcnt(0)
    v_add_f32 v50, v50, v58
    v_add_f32 v51, v51, v59
    v_cvt_pk_bf16_f32 v51, v50, v51
    v_lshlrev_b32 v50, 16, v51
    v_and_b32 v51, 0xffff0000, v51
    v_add_f32 v50, v50, v26
    v_add_f32 v51, v51, v27
    v_cvt_pk_bf16_f32 v52, v44, v46
    v_cvt_pk_bf16_f32 v53, v48, v50
    buffer_store_dwordx2 v[52:53], v0, s[8:11], s55 offen offset:0
    v_cvt_pk_bf16_f32 v54, v45, v47
    v_cvt_pk_bf16_f32 v55, v49, v51
    buffer_store_dwordx2 v[54:55], v0, s[8:11], s55 offen offset:896
    v_mfma_f32_16x16x32_bf16 v[40:43], v[208:211], v[64:67], 0
    ds_read_b64 v[240:241], v16 offset:2560
    v_mfma_f32_16x16x32_bf16 v[40:43], v[212:215], v[72:75], v[40:43]
    ds_read_b64 v[242:243], v16 offset:2568
    v_mfma_f32_16x16x32_bf16 v[40:43], v[216:219], v[80:83], v[40:43]
    ds_read_b64 v[244:245], v16 offset:2624
    v_mfma_f32_16x16x32_bf16 v[40:43], v[220:223], v[88:91], v[40:43]
    ds_read_b64 v[246:247], v16 offset:2632
    v_mfma_f32_16x16x32_bf16 v[40:43], v[192:195], v[96:99], v[40:43]
    ds_read_b64 v[64:65], v16 offset:2688
    v_mfma_f32_16x16x32_bf16 v[40:43], v[196:199], v[104:107], v[40:43]
    ds_read_b64 v[66:67], v16 offset:2696
    v_mfma_f32_16x16x32_bf16 v[40:43], v[200:203], v[112:115], v[40:43]
    ds_read_b64 v[208:209], v16 offset:2752
    v_mfma_f32_16x16x32_bf16 v[40:43], v[204:207], v[120:123], v[40:43]
    ds_read_b64 v[210:211], v16 offset:2760
    v_mfma_f32_16x16x32_bf16 v[40:43], v[128:131], v[160:163], v[40:43]
    v_mfma_f32_16x16x32_bf16 v[40:43], v[132:135], v[164:167], v[40:43]
    v_mfma_f32_16x16x32_bf16 v[40:43], v[136:139], v[168:171], v[40:43]
    v_mfma_f32_16x16x32_bf16 v[40:43], v[140:143], v[172:175], v[40:43]
    v_mfma_f32_16x16x32_bf16 v[40:43], v[144:147], v[176:179], v[40:43]
    v_mfma_f32_16x16x32_bf16 v[40:43], v[148:151], v[180:183], v[40:43]
    v_mfma_f32_16x16x32_bf16 v[40:43], v[152:155], v[184:187], v[40:43]
    v_mfma_f32_16x16x32_bf16 v[40:43], v[156:159], v[188:191], v[40:43]
    v_mfma_f32_16x16x32_bf16 v[36:39], v[100:103], v[224:227], v[36:39]
    v_mfma_f32_16x16x32_bf16 v[36:39], v[108:111], v[228:231], v[36:39]
    v_mfma_f32_16x16x32_bf16 v[36:39], v[116:119], v[232:235], v[36:39]
    v_mfma_f32_16x16x32_bf16 v[36:39], v[124:127], v[236:239], v[36:39]
    s_nop 7
    ds_write_addtid_b32 v36 offset:4128
    ds_write_addtid_b32 v37 offset:12384
    ds_write_addtid_b32 v38 offset:20640
    ds_write_addtid_b32 v39 offset:28896
    ds_read_b32 v21, v19 offset:2560
    ds_read_b32 v23, v19 offset:19200
    ds_read_b32 v25, v19 offset:35840
    ds_read_b32 v27, v19 offset:52480
    s_waitcnt lgkmcnt(3)
    v_lshlrev_b32 v20, 16, v21
    v_and_b32 v21, 0xffff0000, v21
    v_mul_f32 v20, s40, v20
    v_mul_f32 v21, s40, v21
    v_cvt_pk_bf16_f32 v21, v20, v21
    v_lshlrev_b32 v20, 16, v21
    v_and_b32 v21, 0xffff0000, v21
    s_waitcnt lgkmcnt(2)
    v_lshlrev_b32 v22, 16, v23
    v_and_b32 v23, 0xffff0000, v23
    v_mul_f32 v22, s41, v22
    v_mul_f32 v23, s41, v23
    v_cvt_pk_bf16_f32 v23, v22, v23
    v_lshlrev_b32 v22, 16, v23
    v_and_b32 v23, 0xffff0000, v23
    s_waitcnt lgkmcnt(1)
    v_lshlrev_b32 v24, 16, v25
    v_and_b32 v25, 0xffff0000, v25
    v_mul_f32 v24, s42, v24
    v_mul_f32 v25, s42, v25
    v_cvt_pk_bf16_f32 v25, v24, v25
    v_lshlrev_b32 v24, 16, v25
    s_barrier
    v_mfma_f32_16x16x32_bf16 v[40:43], v[68:71], v[224:227], v[40:43]
    v_mfma_f32_16x16x32_bf16 v[40:43], v[76:79], v[228:231], v[40:43]
    v_mfma_f32_16x16x32_bf16 v[40:43], v[84:87], v[232:235], v[40:43]
    v_mfma_f32_16x16x32_bf16 v[40:43], v[92:95], v[236:239], v[40:43]
    v_mfma_f32_16x16x32_bf16 v[40:43], v[100:103], v[240:243], v[40:43]
    v_mfma_f32_16x16x32_bf16 v[40:43], v[108:111], v[244:247], v[40:43]
    v_mfma_f32_16x16x32_bf16 v[40:43], v[116:119], v[64:67], v[40:43]
    v_mfma_f32_16x16x32_bf16 v[40:43], v[124:127], v[208:211], v[40:43]
    s_nop 7
    ds_write_addtid_b32 v40 offset:6192
    ds_write_addtid_b32 v41 offset:14448
    ds_write_addtid_b32 v42 offset:22704
    ds_write_addtid_b32 v43 offset:30960
    v_and_b32 v25, 0xffff0000, v25
    s_waitcnt lgkmcnt(4)
    v_lshlrev_b32 v26, 16, v27
    v_and_b32 v27, 0xffff0000, v27
    v_mul_f32 v26, s43, v26
    v_mul_f32 v27, s43, v27
    v_cvt_pk_bf16_f32 v27, v26, v27
    v_lshlrev_b32 v26, 16, v27
    v_and_b32 v27, 0xffff0000, v27
    s_waitcnt lgkmcnt(0)
    s_barrier
    ds_read_b64 v[44:45], v18 offset:7216
    ds_read_b64 v[52:53], v18 offset:7728
    ds_read_b64 v[46:47], v18 offset:7472
    ds_read_b64 v[54:55], v18 offset:7984
    ds_read_b64 v[48:49], v18 offset:6192
    ds_read_b64 v[56:57], v18 offset:6704
    ds_read_b64 v[50:51], v18 offset:6448
    ds_read_b64 v[58:59], v18 offset:6960
    s_mov_b32 s55, 1146880
    s_waitcnt lgkmcnt(6)
    v_add_f32 v44, v44, v52
    v_add_f32 v45, v45, v53
    v_cvt_pk_bf16_f32 v45, v44, v45
    v_lshlrev_b32 v44, 16, v45
    v_and_b32 v45, 0xffff0000, v45
    v_add_f32 v44, v44, v20
    v_add_f32 v45, v45, v21
    s_waitcnt lgkmcnt(4)
    v_add_f32 v46, v46, v54
    v_add_f32 v47, v47, v55
    v_cvt_pk_bf16_f32 v47, v46, v47
    v_lshlrev_b32 v46, 16, v47
    v_and_b32 v47, 0xffff0000, v47
    v_add_f32 v46, v46, v22
    v_add_f32 v47, v47, v23
    s_waitcnt lgkmcnt(2)
    v_add_f32 v48, v48, v56
    v_add_f32 v49, v49, v57
    v_cvt_pk_bf16_f32 v49, v48, v49
    v_lshlrev_b32 v48, 16, v49
    v_and_b32 v49, 0xffff0000, v49
    v_add_f32 v48, v48, v24
    v_add_f32 v49, v49, v25
    s_waitcnt lgkmcnt(0)
    v_add_f32 v50, v50, v58
    v_add_f32 v51, v51, v59
    v_cvt_pk_bf16_f32 v51, v50, v51
    v_lshlrev_b32 v50, 16, v51
    v_and_b32 v51, 0xffff0000, v51
    v_add_f32 v50, v50, v26
    v_add_f32 v51, v51, v27
    v_cvt_pk_bf16_f32 v52, v44, v46
    v_cvt_pk_bf16_f32 v53, v48, v50
    buffer_store_dwordx2 v[52:53], v0, s[8:11], s55 offen offset:0
    v_cvt_pk_bf16_f32 v54, v45, v47
    v_cvt_pk_bf16_f32 v55, v49, v51
    buffer_store_dwordx2 v[54:55], v0, s[8:11], s55 offen offset:896
    s_endpgm
.p2align 6
L_t6:
    s_branch L_tback
    s_nop 0
L_cv6:
    s_setprio 1
    s_mul_i32 s48, s33, 4608
    s_add_u32 s48, s48, 130560
    v_and_b32 v46, 31, v1
    v_lshrrev_b32 v47, 5, v1
    v_lshlrev_b32 v250, 4, v46
    s_waitcnt lgkmcnt(7)
    v_mfma_f32_32x32x16_f16 v[224:239], v[192:195], v[128:131], 0
    v_lshl_add_u32 v250, v47, 3, v250
    s_add_u32 s3, s48, 4088
    v_sub_u32 v250, s3, v250
    v_lshlrev_b32 v251, 4, v1
    s_xor_b32 s3, s15, s34
    s_waitcnt lgkmcnt(6)
    v_mfma_f32_32x32x16_f16 v[224:239], v[196:199], v[132:135], v[224:239]
    s_lshl_b32 s3, s3, 2
    s_and_b32 s57, s32, 3
    s_add_u32 s3, s3, s57
    s_lshl_b32 s3, s3, 11
    s_add_u32 s3, s3, s96
    s_waitcnt lgkmcnt(5)
    v_mfma_f32_32x32x16_f16 v[224:239], v[200:203], v[136:139], v[224:239]
    s_sub_u32 s3, s3, 32768
    v_add_u32 v249, s3, v251
    s_add_u32 s3, s48, 1008
    v_sub_u32 v251, s3, v251
    v_and_b32 v46, 15, v1
    s_waitcnt lgkmcnt(4)
    v_mfma_f32_32x32x16_f16 v[224:239], v[204:207], v[140:143], v[224:239]
    v_and_b32 v47, 48, v1
    v_add_u32 v48, 1, v46
    v_and_b32 v49, 3, v48
    v_and_b32 v48, 28, v48
    v_mul_u32_u24 v49, 4160, v49
    s_waitcnt lgkmcnt(3)
    v_mfma_f32_32x32x16_f16 v[224:239], v[208:211], v[144:147], v[224:239]
    v_lshl_add_u32 v48, v48, 1, v47
    s_and_b32 s57, s32, 2
    s_lshl_b32 s57, s57, 7
    s_mul_i32 s3, s33, 16640
    s_add_u32 s3, s3, s57
    s_waitcnt lgkmcnt(2)
    v_mfma_f32_32x32x16_f16 v[224:239], v[212:215], v[148:151], v[224:239]
    s_add_u32 s3, s3, 64000
    v_add3_u32 v16, v48, v49, s3
    s_add_u32 s3, s48, s57
    s_add_u32 s3, s3, 480
    v_lshlrev_b32 v48, 5, v46
    s_waitcnt lgkmcnt(1)
    v_mfma_f32_32x32x16_f16 v[224:239], v[216:219], v[152:155], v[224:239]
    v_add_u32 v49, s3, v47
    v_sub_u32 v17, v49, v48
    s_mov_b32 s44, 0x05040100
    s_mov_b32 s45, 0x07060302
    s_waitcnt lgkmcnt(0)
    v_mfma_f32_32x32x16_f16 v[224:239], v[220:223], v[156:159], v[224:239]
    s_waitcnt vmcnt(5)
    v_readfirstlane_b32 s3, v248
    s_nop 1
    s_mul_i32 s3, s3, 0x9e3779b1
    s_add_u32 s3, s3, 0x7f4a7c15
    s_getreg_b32 s97, hwreg(HW_REG_XCC_ID)
    s_and_b32 s97, s97, 7
    s_add_u32 s97, s97, 1
    s_xor_b32 s97, s97, s3
    s_mov_b32 s99, s3
    v_mov_b32 v60, s97
    v_mul_f32 v224, v224, v43
    ds_write_addtid_b32 v224 offset:0
    v_mul_f32 v225, v225, v43
    ds_write_addtid_b32 v225 offset:2064
    v_mul_f32 v226, v226, v43
    ds_write_addtid_b32 v226 offset:4128
    v_mul_f32 v227, v227, v43
    ds_write_addtid_b32 v227 offset:6192
    v_mul_f32 v228, v228, v43
    ds_write_addtid_b32 v228 offset:8256
    v_mul_f32 v229, v229, v43
    ds_write_addtid_b32 v229 offset:10320
    v_mul_f32 v230, v230, v43
    ds_write_addtid_b32 v230 offset:12384
    v_mul_f32 v231, v231, v43
    ds_write_addtid_b32 v231 offset:14448
    v_mul_f32 v232, v232, v43
    ds_write_addtid_b32 v232 offset:16512
    v_mul_f32 v233, v233, v43
    ds_write_addtid_b32 v233 offset:18576
    v_mul_f32 v234, v234, v43
    ds_write_addtid_b32 v234 offset:20640
    v_mul_f32 v235, v235, v43
    ds_write_addtid_b32 v235 offset:22704
    v_mul_f32 v236, v236, v43
    ds_write_addtid_b32 v236 offset:24768
    s_setprio 0
    s_waitcnt vmcnt(2)
    s_add_u32 s3, s47, 61000
    s_mov_b32 m0, s3
    v_mov_b32_dpp v14, v12 wave_ror:1 row_mask:0xf bank_mask:0xf
    v_mov_b32_dpp v15, v13 wave_ror:1 row_mask:0xf bank_mask:0xf
    v_mov_b32_dpp v12, v6 wave_shr:1 row_mask:0xf bank_mask:0xf
    v_mov_b32_dpp v13, v7 wave_shr:1 row_mask:0xf bank_mask:0xf
    v_perm_b32 v44, v6, v4, s44
    v_perm_b32 v45, v4, v12, s44
    v_perm_b32 v46, v6, v4, s45
    v_perm_b32 v47, v4, v12, s45
    v_perm_b32 v48, v7, v5, s44
    v_perm_b32 v49, v5, v13, s44
    v_perm_b32 v50, v7, v5, s45
    v_perm_b32 v51, v5, v13, s45
    ds_write_addtid_b32 v44 offset:3032
    ds_write_addtid_b32 v44 offset:11348
    ds_write_addtid_b32 v45 offset:15504
    ds_write_addtid_b32 v45 offset:7188
    ds_write_addtid_b32 v46 offset:19672
    ds_write_addtid_b32 v46 offset:27988
    ds_write_addtid_b32 v47 offset:32144
    ds_write_addtid_b32 v47 offset:23828
    ds_write_addtid_b32 v48 offset:36312
    ds_write_addtid_b32 v48 offset:44628
    ds_write_addtid_b32 v49 offset:48784
    ds_write_addtid_b32 v49 offset:40468
    ds_write_addtid_b32 v50 offset:52952
    ds_write_addtid_b32 v50 offset:61268
    ds_write_addtid_b32 v51 offset:65424
    ds_write_addtid_b32 v51 offset:57108
    s_mov_b32 m0, s46
    s_waitcnt lgkmcnt(0)
    s_setprio 0
    s_barrier
    s_waitcnt vmcnt(0)
    s_add_u32 s3, s47, 62024
    s_mov_b32 m0, s3
    v_mov_b32_dpp v14, v10 wave_shr:1 row_mask:0xf bank_mask:0xf
    v_mov_b32_dpp v15, v11 wave_shr:1 row_mask:0xf bank_mask:0xf
    v_perm_b32 v44, v10, v8, s44
    v_perm_b32 v45, v8, v14, s44
    v_perm_b32 v46, v10, v8, s45
    v_perm_b32 v47, v8, v14, s45
    v_perm_b32 v48, v11, v9, s44
    v_perm_b32 v49, v9, v15, s44
    v_perm_b32 v50, v11, v9, s45
    v_perm_b32 v51, v9, v15, s45
    ds_write_addtid_b32 v44 offset:3032
    ds_write_addtid_b32 v44 offset:11348
    ds_write_addtid_b32 v45 offset:15504
    ds_write_addtid_b32 v45 offset:7188
    ds_write_addtid_b32 v46 offset:19672
    ds_write_addtid_b32 v46 offset:27988
    ds_write_addtid_b32 v47 offset:32144
    ds_write_addtid_b32 v47 offset:23828
    ds_write_addtid_b32 v48 offset:36312
    ds_write_addtid_b32 v48 offset:44628
    ds_write_addtid_b32 v49 offset:48784
    ds_write_addtid_b32 v49 offset:40468
    ds_write_addtid_b32 v50 offset:52952
    ds_write_addtid_b32 v50 offset:61268
    ds_write_addtid_b32 v51 offset:65424
    ds_write_addtid_b32 v51 offset:57108
    s_mov_b32 m0, s46
    ds_read_b64 v[64:65], v16 offset:512
    ds_read_b64 v[66:67], v16 offset:520
    ds_read_b64 v[68:69], v16 offset:576
    ds_read_b64 v[70:71], v16 offset:584
    ds_read_b64 v[72:73], v16 offset:640
    ds_read_b64 v[74:75], v16 offset:648
    ds_read_b64 v[76:77], v16 offset:704
    ds_read_b64 v[78:79], v16 offset:712
    s_waitcnt lgkmcnt(8)
    s_setprio 1
    s_barrier
    s_mov_b32 s58, 0
    v_mov_b32 v213, v60
    global_load_dwordx4 v[208:211], v249, s[62:63] nt
    s_mov_b64 exec, 1
    global_load_dwordx2 v[212:213], v249, s[62:63] offset:1024 nt
    s_mov_b64 exec, -1
    ds_read_b64 v[80:81], v16 offset:0
    ds_read_b64 v[82:83], v16 offset:8
    ds_read_b64 v[84:85], v16 offset:64
    ds_read_b64 v[86:87], v16 offset:72
    ds_read_b64 v[88:89], v16 offset:128
    ds_read_b64 v[90:91], v16 offset:136
    ds_read_b64 v[92:93], v16 offset:192
    ds_read_b64 v[94:95], v16 offset:200
    ds_read_b64 v[96:97], v16 offset:1536
    ds_read_b64 v[98:99], v16 offset:1544
    ds_read_b64 v[100:101], v16 offset:1600
    ds_read_b64 v[102:103], v16 offset:1608
    ds_read_b64 v[104:105], v16 offset:1664
    ds_read_b64 v[106:107], v16 offset:1672
    ds_read_b64 v[108:109], v16 offset:1728
    ds_read_b64 v[110:111], v16 offset:1736
    ds_read_b64 v[112:113], v16 offset:1024
    ds_read_b64 v[114:115], v16 offset:1032
    ds_read_b64 v[116:117], v16 offset:1088
    ds_read_b64 v[118:119], v16 offset:1096
    ds_read_b64 v[120:121], v16 offset:1152
    ds_read_b64 v[122:123], v16 offset:1160
    ds_read_b64 v[124:125], v16 offset:1216
    ds_read_b64 v[126:127], v16 offset:1224
    s_branch L_pw16
L_poll15:
    s_cmp_lg_u32 s58, 16
    s_cbranch_scc1 L_pt20
    v_xor_b32 v249, 0x2000, v249
L_pq19:
    global_load_dwordx4 v[208:211], v249, s[62:63] nt
    s_mov_b64 exec, 1
    global_load_dwordx2 v[212:213], v249, s[62:63] offset:1024 nt
    s_mov_b64 exec, -1
    s_waitcnt vmcnt(0)
    v_xor_b32 v240, v211, v60
    v_xor_b32 v241, v213, v60
    v_or_b32 v240, v240, v241
    v_cmp_ne_u32 vcc, 0, v240
    s_cbranch_vccnz L_pq19
    v_mov_b32 v211, s99
    v_mov_b32 v213, s99
    v_xor_b32 v249, 0x4000, v249
    global_store_dwordx4 v249, v[208:211], s[62:63] sc1
    s_mov_b64 exec, 1
    global_store_dwordx2 v249, v[212:213], s[62:63] offset:1024 sc1
    s_mov_b64 exec, -1
    s_waitcnt vmcnt(0)
    v_xor_b32 v249, 0x6000, v249
L_pt20:
    s_cmp_lt_u32 s58, 16
    s_cbranch_scc1 L_ps18
    v_xor_b32 v249, 0x4000, v249
    s_xor_b32 s3, s97, s99
    v_xor_b32 v60, s3, v60
L_ps18:
    v_mov_b32 v213, v60
    global_load_dwordx4 v[208:211], v249, s[62:63] sc1
    s_mov_b64 exec, 1
    global_load_dwordx2 v[212:213], v249, s[62:63] offset:1024 sc1
    s_mov_b64 exec, -1
L_pw16:
    s_waitcnt vmcnt(0)
    v_xor_b32 v240, v211, v60
    v_xor_b32 v241, v213, v60
    v_or_b32 v240, v240, v241
    v_cmp_ne_u32 vcc, 0, v240
    s_cbranch_vccz L_po17
    s_add_u32 s58, s58, 1
    s_cmp_lt_u32 s58, 2000000
    s_cbranch_scc1 L_poll15
L_po17:
    v_permlane32_swap_b32 v211, v210
    s_mov_b64 exec, 1
    v_mov_b32 v210, v212
    s_mov_b64 exec, -1
    v_lshlrev_b32 v224, 16, v208
    v_and_b32 v225, 0xffff0000, v208
    v_lshlrev_b32 v226, 16, v209
    v_and_b32 v227, 0xffff0000, v209
    v_lshlrev_b32 v228, 16, v210
    v_and_b32 v229, 0xffff0000, v210
    v_lshlrev_b32 v230, 16, v211
    v_and_b32 v231, 0xffff0000, v211
    v_cvt_pk_bf16_f32 v240, v227, v226
    v_cvt_pk_bf16_f32 v241, v225, v224
    v_mov_b32_dpp v242, v228 wave_rol:1 row_mask:0xf bank_mask:0xf
    ds_write_b64 v250, v[240:241]
    v_cvt_pk_bf16_f32 v245, v230, v230
    v_cvt_pk_bf16_f32 v246, v230, v229
    v_cvt_pk_bf16_f32 v247, v228, v228
    v_cvt_pk_bf16_f32 v244, v242, v231
    s_mov_b32 exec_lo, 0
    ds_write_b128 v251, v[244:247] offset:3072
    s_mov_b32 exec_lo, -1
    s_waitcnt lgkmcnt(0)
    s_setprio 1
    s_barrier
    ds_read_b128 v[128:131], v17 offset:3584
    ds_read_b128 v[132:135], v17 offset:3648
    ds_read_b128 v[136:139], v17 offset:3712
    ds_read_b128 v[140:143], v17 offset:3776
    ds_read_b128 v[144:147], v17 offset:3072
    ds_read_b128 v[148:151], v17 offset:3136
    ds_read_b128 v[152:155], v17 offset:3200
    ds_read_b128 v[156:159], v17 offset:3264
    s_waitcnt lgkmcnt(7)
    v_mfma_f32_16x16x32_bf16 v[28:31], v[128:131], v[64:67], 0
    ds_read_b128 v[160:163], v17 offset:2560
    s_waitcnt lgkmcnt(7)
    v_mfma_f32_16x16x32_bf16 v[28:31], v[132:135], v[68:71], v[28:31]
    ds_read_b128 v[164:167], v17 offset:2624
    s_waitcnt lgkmcnt(7)
    v_mfma_f32_16x16x32_bf16 v[28:31], v[136:139], v[72:75], v[28:31]
    ds_read_b128 v[168:171], v17 offset:2688
    s_waitcnt lgkmcnt(7)
    v_mfma_f32_16x16x32_bf16 v[28:31], v[140:143], v[76:79], v[28:31]
    ds_read_b128 v[172:175], v17 offset:2752
    s_waitcnt lgkmcnt(7)
    v_mfma_f32_16x16x32_bf16 v[28:31], v[144:147], v[80:83], v[28:31]
    ds_read_b128 v[176:179], v17 offset:2048
    s_waitcnt lgkmcnt(7)
    v_mfma_f32_16x16x32_bf16 v[28:31], v[148:151], v[84:87], v[28:31]
    ds_read_b128 v[180:183], v17 offset:2112
    s_waitcnt lgkmcnt(7)
    v_mfma_f32_16x16x32_bf16 v[28:31], v[152:155], v[88:91], v[28:31]
    ds_read_b128 v[184:187], v17 offset:2176
    s_waitcnt lgkmcnt(7)
    v_mfma_f32_16x16x32_bf16 v[28:31], v[156:159], v[92:95], v[28:31]
    ds_read_b128 v[188:191], v17 offset:2240
    v_mfma_f32_16x16x32_bf16 v[32:35], v[128:131], v[96:99], 0
    ds_read_b128 v[192:195], v17 offset:1536
    v_mfma_f32_16x16x32_bf16 v[32:35], v[132:135], v[100:103], v[32:35]
    ds_read_b128 v[196:199], v17 offset:1600
    v_mfma_f32_16x16x32_bf16 v[32:35], v[136:139], v[104:107], v[32:35]
    s_nop 1
    ds_write_addtid_b32 v28 offset:0
    v_mfma_f32_16x16x32_bf16 v[32:35], v[140:143], v[108:111], v[32:35]
    ds_write_addtid_b32 v29 offset:8256
    v_mfma_f32_16x16x32_bf16 v[32:35], v[144:147], v[112:115], v[32:35]
    ds_write_addtid_b32 v30 offset:16512
    v_mfma_f32_16x16x32_bf16 v[32:35], v[148:151], v[116:119], v[32:35]
    ds_write_addtid_b32 v31 offset:24768
    v_mfma_f32_16x16x32_bf16 v[32:35], v[152:155], v[120:123], v[32:35]
    ds_read_b128 v[200:203], v17 offset:1664
    s_waitcnt lgkmcnt(1)
    s_barrier
    v_mfma_f32_16x16x32_bf16 v[32:35], v[156:159], v[124:127], v[32:35]
    ds_read_b128 v[204:207], v17 offset:1728
    v_mfma_f32_16x16x32_bf16 v[32:35], v[160:163], v[64:67], v[32:35]
    ds_read_b64 v[216:217], v16 offset:2048
    v_mfma_f32_16x16x32_bf16 v[32:35], v[164:167], v[68:71], v[32:35]
    ds_read_b64 v[218:219], v16 offset:2056
    v_mfma_f32_16x16x32_bf16 v[32:35], v[168:171], v[72:75], v[32:35]
    ds_read_b64 v[220:221], v16 offset:2112
    v_mfma_f32_16x16x32_bf16 v[32:35], v[172:175], v[76:79], v[32:35]
    ds_read_b64 v[222:223], v16 offset:2120
    v_mfma_f32_16x16x32_bf16 v[32:35], v[176:179], v[80:83], v[32:35]
    ds_read_b64 v[208:209], v16 offset:2176
    v_mfma_f32_16x16x32_bf16 v[32:35], v[180:183], v[84:87], v[32:35]
    ds_read_b64 v[210:211], v16 offset:2184
    v_mfma_f32_16x16x32_bf16 v[32:35], v[184:187], v[88:91], v[32:35]
    ds_read_b64 v[212:213], v16 offset:2240
    v_mfma_f32_16x16x32_bf16 v[32:35], v[188:191], v[92:95], v[32:35]
    ds_read_b64 v[214:215], v16 offset:2248
    v_mfma_f32_16x16x32_bf16 v[36:39], v[144:147], v[96:99], 0
    ds_read_b64 v[224:225], v16 offset:2560
    v_mfma_f32_16x16x32_bf16 v[36:39], v[148:151], v[100:103], v[36:39]
    ds_read_b64 v[226:227], v16 offset:2568
    v_mfma_f32_16x16x32_bf16 v[36:39], v[152:155], v[104:107], v[36:39]
    s_nop 1
    ds_write_addtid_b32 v32 offset:2064
    v_mfma_f32_16x16x32_bf16 v[36:39], v[156:159], v[108:111], v[36:39]
    ds_write_addtid_b32 v33 offset:10320
    v_mfma_f32_16x16x32_bf16 v[36:39], v[160:163], v[112:115], v[36:39]
    ds_write_addtid_b32 v34 offset:18576
    v_mfma_f32_16x16x32_bf16 v[36:39], v[164:167], v[116:119], v[36:39]
    ds_write_addtid_b32 v35 offset:26832
    v_mfma_f32_16x16x32_bf16 v[36:39], v[168:171], v[120:123], v[36:39]
    ds_read_b64 v[228:229], v16 offset:2624
    ds_read_b64 v[230:231], v16 offset:2632
    s_waitcnt lgkmcnt(2)
    s_barrier
    v_mfma_f32_16x16x32_bf16 v[36:39], v[172:175], v[124:127], v[36:39]
    ds_read_b64 v[232:233], v16 offset:2688
    v_mfma_f32_16x16x32_bf16 v[36:39], v[176:179], v[64:67], v[36:39]
    ds_read_b64 v[234:235], v16 offset:2696
    v_mfma_f32_16x16x32_bf16 v[36:39], v[180:183], v[68:71], v[36:39]
    ds_read_b64 v[236:237], v16 offset:2752
    v_mfma_f32_16x16x32_bf16 v[36:39], v[184:187], v[72:75], v[36:39]
    ds_read_b64 v[238:239], v16 offset:2760
    v_mfma_f32_16x16x32_bf16 v[36:39], v[188:191], v[76:79], v[36:39]
    ds_read_b128 v[240:243], v17 offset:1024
    v_mfma_f32_16x16x32_bf16 v[36:39], v[192:195], v[80:83], v[36:39]
    ds_read_b128 v[244:247], v17 offset:1088
    v_mfma_f32_16x16x32_bf16 v[36:39], v[196:199], v[84:87], v[36:39]
    ds_read_b128 v[248:251], v17 offset:1152
    v_mfma_f32_16x16x32_bf16 v[36:39], v[200:203], v[88:91], v[36:39]
    ds_read_b128 v[252:255], v17 offset:1216
    v_mfma_f32_16x16x32_bf16 v[36:39], v[204:207], v[92:95], v[36:39]
    v_mfma_f32_16x16x32_bf16 v[36:39], v[128:131], v[216:219], v[36:39]
    v_mfma_f32_16x16x32_bf16 v[36:39], v[132:135], v[220:223], v[36:39]
    v_mfma_f32_16x16x32_bf16 v[36:39], v[136:139], v[208:211], v[36:39]
    v_mfma_f32_16x16x32_bf16 v[36:39], v[140:143], v[212:215], v[36:39]
    v_mfma_f32_16x16x32_bf16 v[40:43], v[128:131], v[224:227], 0
    s_waitcnt lgkmcnt(8)
    v_mfma_f32_16x16x32_bf16 v[40:43], v[132:135], v[228:231], v[40:43]
    s_waitcnt lgkmcnt(6)
    v_mfma_f32_16x16x32_bf16 v[40:43], v[136:139], v[232:235], v[40:43]
    s_nop 2
    ds_write_addtid_b32 v36 offset:4128
    s_waitcnt lgkmcnt(5)
    v_mfma_f32_16x16x32_bf16 v[40:43], v[140:143], v[236:239], v[40:43]
    ds_write_addtid_b32 v37 offset:12384
    v_mfma_f32_16x16x32_bf16 v[40:43], v[144:147], v[216:219], v[40:43]
    ds_write_addtid_b32 v38 offset:20640
    v_mfma_f32_16x16x32_bf16 v[40:43], v[148:151], v[220:223], v[40:43]
    ds_write_addtid_b32 v39 offset:28896
    v_mfma_f32_16x16x32_bf16 v[40:43], v[152:155], v[208:211], v[40:43]
    s_waitcnt lgkmcnt(0)
    s_barrier
    v_mfma_f32_16x16x32_bf16 v[40:43], v[156:159], v[212:215], v[40:43]
    v_mfma_f32_16x16x32_bf16 v[40:43], v[160:163], v[96:99], v[40:43]
    v_mfma_f32_16x16x32_bf16 v[40:43], v[164:167], v[100:103], v[40:43]
    v_mfma_f32_16x16x32_bf16 v[40:43], v[168:171], v[104:107], v[40:43]
    v_mfma_f32_16x16x32_bf16 v[40:43], v[172:175], v[108:111], v[40:43]
    v_mfma_f32_16x16x32_bf16 v[40:43], v[176:179], v[112:115], v[40:43]
    v_mfma_f32_16x16x32_bf16 v[40:43], v[180:183], v[116:119], v[40:43]
    v_mfma_f32_16x16x32_bf16 v[40:43], v[184:187], v[120:123], v[40:43]
    v_mfma_f32_16x16x32_bf16 v[40:43], v[188:191], v[124:127], v[40:43]
    v_mfma_f32_16x16x32_bf16 v[40:43], v[192:195], v[64:67], v[40:43]
    v_mfma_f32_16x16x32_bf16 v[40:43], v[196:199], v[68:71], v[40:43]
    v_mfma_f32_16x16x32_bf16 v[40:43], v[200:203], v[72:75], v[40:43]
    v_mfma_f32_16x16x32_bf16 v[40:43], v[204:207], v[76:79], v[40:43]
    v_mfma_f32_16x16x32_bf16 v[40:43], v[240:243], v[80:83], v[40:43]
    v_mfma_f32_16x16x32_bf16 v[40:43], v[244:247], v[84:87], v[40:43]
    v_mfma_f32_16x16x32_bf16 v[40:43], v[248:251], v[88:91], v[40:43]
    v_mfma_f32_16x16x32_bf16 v[40:43], v[252:255], v[92:95], v[40:43]
    s_nop 7
    ds_write_addtid_b32 v40 offset:6192
    ds_write_addtid_b32 v41 offset:14448
    ds_write_addtid_b32 v42 offset:22704
    ds_write_addtid_b32 v43 offset:30960
    s_waitcnt lgkmcnt(0)
    s_barrier
    s_endpgm
.p2align 6
L_t7:
    s_branch L_tback
    s_nop 0
L_cv7:
    s_setprio 1
    s_mul_i32 s48, s33, 4608
    s_add_u32 s48, s48, 130560
    v_and_b32 v46, 31, v1
    v_lshrrev_b32 v47, 5, v1
    v_lshlrev_b32 v250, 4, v46
    s_waitcnt lgkmcnt(7)
    v_mfma_f32_32x32x16_f16 v[224:239], v[192:195], v[128:131], 0
    v_lshl_add_u32 v250, v47, 3, v250
    s_add_u32 s3, s48, 4088
    v_sub_u32 v250, s3, v250
    v_lshlrev_b32 v251, 4, v1
    s_xor_b32 s3, s15, s34
    s_waitcnt lgkmcnt(6)
    v_mfma_f32_32x32x16_f16 v[224:239], v[196:199], v[132:135], v[224:239]
    s_lshl_b32 s3, s3, 2
    s_and_b32 s57, s32, 3
    s_add_u32 s3, s3, s57
    s_lshl_b32 s3, s3, 11
    s_add_u32 s3, s3, s96
    s_waitcnt lgkmcnt(5)
    v_mfma_f32_32x32x16_f16 v[224:239], v[200:203], v[136:139], v[224:239]
    s_sub_u32 s3, s3, 32768
    v_add_u32 v249, s3, v251
    s_add_u32 s3, s48, 1008
    v_sub_u32 v251, s3, v251
    v_and_b32 v46, 15, v1
    s_waitcnt lgkmcnt(4)
    v_mfma_f32_32x32x16_f16 v[224:239], v[204:207], v[140:143], v[224:239]
    v_and_b32 v47, 48, v1
    v_add_u32 v48, 1, v46
    v_and_b32 v49, 3, v48
    v_and_b32 v48, 28, v48
    v_mul_u32_u24 v49, 4160, v49
    s_waitcnt lgkmcnt(3)
    v_mfma_f32_32x32x16_f16 v[224:239], v[208:211], v[144:147], v[224:239]
    v_lshl_add_u32 v48, v48, 1, v47
    s_and_b32 s57, s32, 2
    s_lshl_b32 s57, s57, 7
    s_mul_i32 s3, s33, 16640
    s_add_u32 s3, s3, s57
    s_waitcnt lgkmcnt(2)
    v_mfma_f32_32x32x16_f16 v[224:239], v[212:215], v[148:151], v[224:239]
    s_add_u32 s3, s3, 64000
    v_add3_u32 v16, v48, v49, s3
    s_add_u32 s3, s48, s57
    s_add_u32 s3, s3, 480
    v_lshlrev_b32 v48, 5, v46
    s_waitcnt lgkmcnt(1)
    v_mfma_f32_32x32x16_f16 v[224:239], v[216:219], v[152:155], v[224:239]
    v_add_u32 v49, s3, v47
    v_sub_u32 v17, v49, v48
    s_mov_b32 s44, 0x05040100
    s_mov_b32 s45, 0x07060302
    s_waitcnt lgkmcnt(0)
    v_mfma_f32_32x32x16_f16 v[224:239], v[220:223], v[156:159], v[224:239]
    s_waitcnt vmcnt(5)
    v_readfirstlane_b32 s3, v248
    s_nop 1
    s_mul_i32 s3, s3, 0x9e3779b1
    s_add_u32 s3, s3, 0x7f4a7c15
    s_getreg_b32 s97, hwreg(HW_REG_XCC_ID)
    s_and_b32 s97, s97, 7
    s_add_u32 s97, s97, 1
    s_xor_b32 s97, s97, s3
    s_mov_b32 s99, s3
    v_mov_b32 v60, s97
    v_mul_f32 v224, v224, v43
    ds_write_addtid_b32 v224 offset:0
    v_mul_f32 v225, v225, v43
    ds_write_addtid_b32 v225 offset:2064
    v_mul_f32 v226, v226, v43
    ds_write_addtid_b32 v226 offset:4128
    v_mul_f32 v227, v227, v43
    ds_write_addtid_b32 v227 offset:6192
    v_mul_f32 v228, v228, v43
    ds_write_addtid_b32 v228 offset:8256
    v_mul_f32 v229, v229, v43
    ds_write_addtid_b32 v229 offset:10320
    v_mul_f32 v230, v230, v43
    ds_write_addtid_b32 v230 offset:12384
    v_mul_f32 v231, v231, v43
    ds_write_addtid_b32 v231 offset:14448
    v_mul_f32 v232, v232, v43
    ds_write_addtid_b32 v232 offset:16512
    v_mul_f32 v233, v233, v43
    ds_write_addtid_b32 v233 offset:18576
    v_mul_f32 v234, v234, v43
    ds_write_addtid_b32 v234 offset:20640
    v_mul_f32 v235, v235, v43
    ds_write_addtid_b32 v235 offset:22704
    v_mul_f32 v236, v236, v43
    ds_write_addtid_b32 v236 offset:24768
    s_setprio 0
    s_waitcnt vmcnt(2)
    s_add_u32 s3, s47, 61000
    s_mov_b32 m0, s3
    v_mov_b32_dpp v14, v12 wave_ror:1 row_mask:0xf bank_mask:0xf
    v_mov_b32_dpp v15, v13 wave_ror:1 row_mask:0xf bank_mask:0xf
    v_mov_b32_dpp v12, v6 wave_shr:1 row_mask:0xf bank_mask:0xf
    v_mov_b32_dpp v13, v7 wave_shr:1 row_mask:0xf bank_mask:0xf
    v_perm_b32 v44, v6, v4, s44
    v_perm_b32 v45, v4, v12, s44
    v_perm_b32 v46, v6, v4, s45
    v_perm_b32 v47, v4, v12, s45
    v_perm_b32 v48, v7, v5, s44
    v_perm_b32 v49, v5, v13, s44
    v_perm_b32 v50, v7, v5, s45
    v_perm_b32 v51, v5, v13, s45
    ds_write_addtid_b32 v44 offset:3032
    ds_write_addtid_b32 v44 offset:11348
    ds_write_addtid_b32 v45 offset:15504
    ds_write_addtid_b32 v45 offset:7188
    ds_write_addtid_b32 v46 offset:19672
    ds_write_addtid_b32 v46 offset:27988
    ds_write_addtid_b32 v47 offset:32144
    ds_write_addtid_b32 v47 offset:23828
    ds_write_addtid_b32 v48 offset:36312
    ds_write_addtid_b32 v48 offset:44628
    ds_write_addtid_b32 v49 offset:48784
    ds_write_addtid_b32 v49 offset:40468
    ds_write_addtid_b32 v50 offset:52952
    ds_write_addtid_b32 v50 offset:61268
    ds_write_addtid_b32 v51 offset:65424
    ds_write_addtid_b32 v51 offset:57108
    s_mov_b32 m0, s46
    s_waitcnt lgkmcnt(0)
    s_setprio 0
    s_barrier
    s_waitcnt vmcnt(0)
    s_add_u32 s3, s47, 62024
    s_mov_b32 m0, s3
    v_mov_b32_dpp v14, v10 wave_shr:1 row_mask:0xf bank_mask:0xf
    v_mov_b32_dpp v15, v11 wave_shr:1 row_mask:0xf bank_mask:0xf
    v_perm_b32 v44, v10, v8, s44
    v_perm_b32 v45, v8, v14, s44
    v_perm_b32 v46, v10, v8, s45
    v_perm_b32 v47, v8, v14, s45
    v_perm_b32 v48, v11, v9, s44
    v_perm_b32 v49, v9, v15, s44
    v_perm_b32 v50, v11, v9, s45
    v_perm_b32 v51, v9, v15, s45
    ds_write_addtid_b32 v44 offset:3032
    ds_write_addtid_b32 v44 offset:11348
    ds_write_addtid_b32 v45 offset:15504
    ds_write_addtid_b32 v45 offset:7188
    ds_write_addtid_b32 v46 offset:19672
    ds_write_addtid_b32 v46 offset:27988
    ds_write_addtid_b32 v47 offset:32144
    ds_write_addtid_b32 v47 offset:23828
    ds_write_addtid_b32 v48 offset:36312
    ds_write_addtid_b32 v48 offset:44628
    ds_write_addtid_b32 v49 offset:48784
    ds_write_addtid_b32 v49 offset:40468
    ds_write_addtid_b32 v50 offset:52952
    ds_write_addtid_b32 v50 offset:61268
    ds_write_addtid_b32 v51 offset:65424
    ds_write_addtid_b32 v51 offset:57108
    s_mov_b32 m0, s46
    ds_read_b64 v[64:65], v16 offset:512
    ds_read_b64 v[66:67], v16 offset:520
    ds_read_b64 v[68:69], v16 offset:576
    ds_read_b64 v[70:71], v16 offset:584
    ds_read_b64 v[72:73], v16 offset:640
    ds_read_b64 v[74:75], v16 offset:648
    ds_read_b64 v[76:77], v16 offset:704
    ds_read_b64 v[78:79], v16 offset:712
    s_waitcnt lgkmcnt(8)
    s_setprio 1
    s_barrier
    s_mov_b32 s58, 0
    v_mov_b32 v213, v60
    global_load_dwordx4 v[208:211], v249, s[62:63] nt
    ds_read_b64 v[80:81], v16 offset:0
    ds_read_b64 v[82:83], v16 offset:8
    ds_read_b64 v[84:85], v16 offset:64
    ds_read_b64 v[86:87], v16 offset:72
    ds_read_b64 v[88:89], v16 offset:128
    ds_read_b64 v[90:91], v16 offset:136
    ds_read_b64 v[92:93], v16 offset:192
    ds_read_b64 v[94:95], v16 offset:200
    ds_read_b64 v[96:97], v16 offset:1536
    ds_read_b64 v[98:99], v16 offset:1544
    ds_read_b64 v[100:101], v16 offset:1600
    ds_read_b64 v[102:103], v16 offset:1608
    ds_read_b64 v[104:105], v16 offset:1664
    ds_read_b64 v[106:107], v16 offset:1672
    ds_read_b64 v[108:109], v16 offset:1728
    ds_read_b64 v[110:111], v16 offset:1736
    ds_read_b64 v[112:113], v16 offset:1024
    ds_read_b64 v[114:115], v16 offset:1032
    ds_read_b64 v[116:117], v16 offset:1088
    ds_read_b64 v[118:119], v16 offset:1096
    ds_read_b64 v[120:121], v16 offset:1152
    ds_read_b64 v[122:123], v16 offset:1160
    ds_read_b64 v[124:125], v16 offset:1216
    ds_read_b64 v[126:127], v16 offset:1224
    s_branch L_pw22
L_poll21:
    s_cmp_lg_u32 s58, 16
    s_cbranch_scc1 L_pt26
    v_xor_b32 v249, 0x2000, v249
L_pq25:
    global_load_dwordx4 v[208:211], v249, s[62:63] nt
    s_waitcnt vmcnt(0)
    v_xor_b32 v240, v211, v60
    v_xor_b32 v241, v213, v60
    v_or_b32 v240, v240, v241
    v_cmp_ne_u32 vcc, 0, v240
    s_cbranch_vccnz L_pq25
    v_mov_b32 v211, s99
    v_mov_b32 v213, s99
    v_xor_b32 v249, 0x4000, v249
    global_store_dwordx4 v249, v[208:211], s[62:63] sc1
    s_waitcnt vmcnt(0)
    s_nop 0
    v_xor_b32 v249, 0x6000, v249
L_pt26:
    s_cmp_lt_u32 s58, 16
    s_cbranch_scc1 L_ps24
    v_xor_b32 v249, 0x4000, v249
    s_xor_b32 s3, s97, s99
    v_xor_b32 v60, s3, v60
L_ps24:
    v_mov_b32 v213, v60
    global_load_dwordx4 v[208:211], v249, s[62:63] sc1
L_pw22:
    s_waitcnt vmcnt(0)
    v_xor_b32 v240, v211, v60
    v_xor_b32 v241, v213, v60
    v_or_b32 v240, v240, v241
    v_cmp_ne_u32 vcc, 0, v240
    s_cbranch_vccz L_po23
    s_add_u32 s58, s58, 1
    s_cmp_lt_u32 s58, 2000000
    s_cbranch_scc1 L_poll21
L_po23:
    v_lshlrev_b32 v232, 16, v208
    v_and_b32 v233, 0xffff0000, v208
    v_lshlrev_b32 v234, 16, v209
    v_and_b32 v235, 0xffff0000, v209
    v_lshlrev_b32 v236, 16, v210
    s_mov_b32 vcc_lo, 0xaaaaaaaa
    s_mov_b32 vcc_hi, 0xaaaaaaaa
    v_mov_b32_dpp v240, v234 wave_rol:1 row_mask:0xf bank_mask:0xf
    v_cvt_pk_bf16_f32 v225, v233, v233
    v_cvt_pk_bf16_f32 v226, v233, v232
    v_mov_b32_dpp v240, v232 wave_shl:1 row_mask:0xf bank_mask:0xf
    v_cvt_pk_bf16_f32 v227, v232, v232
    v_mov_b32_dpp v241, v235 wave_rol:1 row_mask:0xf bank_mask:0xf
    v_cvt_pk_bf16_f32 v224, v240, v240
    v_mov_b32_dpp v242, v236 wave_rol:1 row_mask:0xf bank_mask:0xf
    ds_write_b128 v251, v[224:227] offset:2048
    v_mov_b32_dpp v241, v234 wave_shl:1 row_mask:0xf bank_mask:0xf
    v_mov_b32_dpp v242, v235 wave_shl:1 row_mask:0xf bank_mask:0xf
    v_cndmask_b32 v243, v234, v241, vcc
    v_cvt_pk_bf16_f32 v230, v234, v234
    v_cvt_pk_bf16_f32 v231, v234, v234
    v_cvt_pk_bf16_f32 v228, v241, v241
    v_cvt_pk_bf16_f32 v229, v241, v243
    ds_write_b128 v251, v[228:231] offset:1024
    v_cndmask_b32 v243, v235, v242, vcc
    v_cvt_pk_bf16_f32 v246, v235, v235
    v_cvt_pk_bf16_f32 v247, v235, v235
    v_cvt_pk_bf16_f32 v244, v242, v242
    v_cvt_pk_bf16_f32 v245, v242, v243
    ds_write_b128 v251, v[244:247] offset:0
    s_waitcnt lgkmcnt(0)
    s_setprio 1
    s_barrier
    ds_read_b128 v[128:131], v17 offset:3584
    ds_read_b128 v[132:135], v17 offset:3648
    ds_read_b128 v[136:139], v17 offset:3712
    ds_read_b128 v[140:143], v17 offset:3776
    ds_read_b128 v[144:147], v17 offset:3072
    ds_read_b128 v[148:151], v17 offset:3136
    ds_read_b128 v[152:155], v17 offset:3200
    ds_read_b128 v[156:159], v17 offset:3264
    s_waitcnt lgkmcnt(7)
    v_mfma_f32_16x16x32_bf16 v[28:31], v[128:131], v[64:67], 0
    ds_read_b128 v[160:163], v17 offset:2560
    s_waitcnt lgkmcnt(7)
    v_mfma_f32_16x16x32_bf16 v[28:31], v[132:135], v[68:71], v[28:31]
    ds_read_b128 v[164:167], v17 offset:2624
    s_waitcnt lgkmcnt(7)
    v_mfma_f32_16x16x32_bf16 v[28:31], v[136:139], v[72:75], v[28:31]
    ds_read_b128 v[168:171], v17 offset:2688
    s_waitcnt lgkmcnt(7)
    v_mfma_f32_16x16x32_bf16 v[28:31], v[140:143], v[76:79], v[28:31]
    ds_read_b128 v[172:175], v17 offset:2752
    s_waitcnt lgkmcnt(7)
    v_mfma_f32_16x16x32_bf16 v[28:31], v[144:147], v[80:83], v[28:31]
    ds_read_b128 v[176:179], v17 offset:2048
    s_waitcnt lgkmcnt(7)
    v_mfma_f32_16x16x32_bf16 v[28:31], v[148:151], v[84:87], v[28:31]
    ds_read_b128 v[180:183], v17 offset:2112
    s_waitcnt lgkmcnt(7)
    v_mfma_f32_16x16x32_bf16 v[28:31], v[152:155], v[88:91], v[28:31]
    ds_read_b128 v[184:187], v17 offset:2176
    s_waitcnt lgkmcnt(7)
    v_mfma_f32_16x16x32_bf16 v[28:31], v[156:159], v[92:95], v[28:31]
    ds_read_b128 v[188:191], v17 offset:2240
    v_mfma_f32_16x16x32_bf16 v[32:35], v[128:131], v[96:99], 0
    ds_read_b128 v[192:195], v17 offset:1536
    v_mfma_f32_16x16x32_bf16 v[32:35], v[132:135], v[100:103], v[32:35]
    ds_read_b128 v[196:199], v17 offset:1600
    v_mfma_f32_16x16x32_bf16 v[32:35], v[136:139], v[104:107], v[32:35]
    s_nop 1
    ds_write_addtid_b32 v28 offset:0
    v_mfma_f32_16x16x32_bf16 v[32:35], v[140:143], v[108:111], v[32:35]
    ds_write_addtid_b32 v29 offset:8256
    v_mfma_f32_16x16x32_bf16 v[32:35], v[144:147], v[112:115], v[32:35]
    ds_write_addtid_b32 v30 offset:16512
    v_mfma_f32_16x16x32_bf16 v[32:35], v[148:151], v[116:119], v[32:35]
    ds_write_addtid_b32 v31 offset:24768
    v_mfma_f32_16x16x32_bf16 v[32:35], v[152:155], v[120:123], v[32:35]
    ds_read_b128 v[200:203], v17 offset:1664
    s_waitcnt lgkmcnt(1)
    s_barrier
    v_mfma_f32_16x16x32_bf16 v[32:35], v[156:159], v[124:127], v[32:35]
    ds_read_b128 v[204:207], v17 offset:1728
    v_mfma_f32_16x16x32_bf16 v[32:35], v[160:163], v[64:67], v[32:35]
    ds_read_b64 v[216:217], v16 offset:2048
    v_mfma_f32_16x16x32_bf16 v[32:35], v[164:167], v[68:71], v[32:35]
    ds_read_b64 v[218:219], v16 offset:2056
    v_mfma_f32_16x16x32_bf16 v[32:35], v[168:171], v[72:75], v[32:35]
    ds_read_b64 v[220:221], v16 offset:2112
    v_mfma_f32_16x16x32_bf16 v[32:35], v[172:175], v[76:79], v[32:35]
    ds_read_b64 v[222:223], v16 offset:2120
    v_mfma_f32_16x16x32_bf16 v[32:35], v[176:179], v[80:83], v[32:35]
    ds_read_b64 v[208:209], v16 offset:2176
    v_mfma_f32_16x16x32_bf16 v[32:35], v[180:183], v[84:87], v[32:35]
    ds_read_b64 v[210:211], v16 offset:2184
    v_mfma_f32_16x16x32_bf16 v[32:35], v[184:187], v[88:91], v[32:35]
    ds_read_b64 v[212:213], v16 offset:2240
    v_mfma_f32_16x16x32_bf16 v[32:35], v[188:191], v[92:95], v[32:35]
    ds_read_b64 v[214:215], v16 offset:2248
    v_mfma_f32_16x16x32_bf16 v[36:39], v[144:147], v[96:99], 0
    ds_read_b64 v[224:225], v16 offset:2560
    v_mfma_f32_16x16x32_bf16 v[36:39], v[148:151], v[100:103], v[36:39]
    ds_read_b64 v[226:227], v16 offset:2568
    v_mfma_f32_16x16x32_bf16 v[36:39], v[152:155], v[104:107], v[36:39]
    s_nop 1
    ds_write_addtid_b32 v32 offset:2064
    v_mfma_f32_16x16x32_bf16 v[36:39], v[156:159], v[108:111], v[36:39]
    ds_write_addtid_b32 v33 offset:10320
    v_mfma_f32_16x16x32_bf16 v[36:39], v[160:163], v[112:115], v[36:39]
    ds_write_addtid_b32 v34 offset:18576
    v_mfma_f32_16x16x32_bf16 v[36:39], v[164:167], v[116:119], v[36:39]
    ds_write_addtid_b32 v35 offset:26832
    v_mfma_f32_16x16x32_bf16 v[36:39], v[168:171], v[120:123], v[36:39]
    ds_read_b64 v[228:229], v16 offset:2624
    ds_read_b64 v[230:231], v16 offset:2632
    s_waitcnt lgkmcnt(2)
    s_barrier
    v_mfma_f32_16x16x32_bf16 v[36:39], v[172:175], v[124:127], v[36:39]
    ds_read_b64 v[232:233], v16 offset:2688
    v_mfma_f32_16x16x32_bf16 v[36:39], v[176:179], v[64:67], v[36:39]
    ds_read_b64 v[234:235], v16 offset:2696
    v_mfma_f32_16x16x32_bf16 v[36:39], v[180:183], v[68:71], v[36:39]
    ds_read_b64 v[236:237], v16 offset:2752
    v_mfma_f32_16x16x32_bf16 v[36:39], v[184:187], v[72:75], v[36:39]
    ds_read_b64 v[238:239], v16 offset:2760
    v_mfma_f32_16x16x32_bf16 v[36:39], v[188:191], v[76:79], v[36:39]
    ds_read_b128 v[240:243], v17 offset:1024
    v_mfma_f32_16x16x32_bf16 v[36:39], v[192:195], v[80:83], v[36:39]
    ds_read_b128 v[244:247], v17 offset:1088
    v_mfma_f32_16x16x32_bf16 v[36:39], v[196:199], v[84:87], v[36:39]
    ds_read_b128 v[248:251], v17 offset:1152
    v_mfma_f32_16x16x32_bf16 v[36:39], v[200:203], v[88:91], v[36:39]
    ds_read_b128 v[252:255], v17 offset:1216
    v_mfma_f32_16x16x32_bf16 v[36:39], v[204:207], v[92:95], v[36:39]
    v_mfma_f32_16x16x32_bf16 v[36:39], v[128:131], v[216:219], v[36:39]
    v_mfma_f32_16x16x32_bf16 v[36:39], v[132:135], v[220:223], v[36:39]
    v_mfma_f32_16x16x32_bf16 v[36:39], v[136:139], v[208:211], v[36:39]
    v_mfma_f32_16x16x32_bf16 v[36:39], v[140:143], v[212:215], v[36:39]
    v_mfma_f32_16x16x32_bf16 v[40:43], v[128:131], v[224:227], 0
    s_waitcnt lgkmcnt(8)
    v_mfma_f32_16x16x32_bf16 v[40:43], v[132:135], v[228:231], v[40:43]
    s_waitcnt lgkmcnt(6)
    v_mfma_f32_16x16x32_bf16 v[40:43], v[136:139], v[232:235], v[40:43]
    s_nop 2
    ds_write_addtid_b32 v36 offset:4128
    s_waitcnt lgkmcnt(5)
    v_mfma_f32_16x16x32_bf16 v[40:43], v[140:143], v[236:239], v[40:43]
    ds_write_addtid_b32 v37 offset:12384
    v_mfma_f32_16x16x32_bf16 v[40:43], v[144:147], v[216:219], v[40:43]
    ds_write_addtid_b32 v38 offset:20640
    v_mfma_f32_16x16x32_bf16 v[40:43], v[148:151], v[220:223], v[40:43]
    ds_write_addtid_b32 v39 offset:28896
    v_mfma_f32_16x16x32_bf16 v[40:43], v[152:155], v[208:211], v[40:43]
    s_waitcnt lgkmcnt(0)
    s_barrier
    v_mfma_f32_16x16x32_bf16 v[40:43], v[156:159], v[212:215], v[40:43]
    v_mfma_f32_16x16x32_bf16 v[40:43], v[160:163], v[96:99], v[40:43]
    v_mfma_f32_16x16x32_bf16 v[40:43], v[164:167], v[100:103], v[40:43]
    v_mfma_f32_16x16x32_bf16 v[40:43], v[168:171], v[104:107], v[40:43]
    v_mfma_f32_16x16x32_bf16 v[40:43], v[172:175], v[108:111], v[40:43]
    v_mfma_f32_16x16x32_bf16 v[40:43], v[176:179], v[112:115], v[40:43]
    v_mfma_f32_16x16x32_bf16 v[40:43], v[180:183], v[116:119], v[40:43]
    v_mfma_f32_16x16x32_bf16 v[40:43], v[184:187], v[120:123], v[40:43]
    v_mfma_f32_16x16x32_bf16 v[40:43], v[188:191], v[124:127], v[40:43]
    v_mfma_f32_16x16x32_bf16 v[40:43], v[192:195], v[64:67], v[40:43]
    v_mfma_f32_16x16x32_bf16 v[40:43], v[196:199], v[68:71], v[40:43]
    v_mfma_f32_16x16x32_bf16 v[40:43], v[200:203], v[72:75], v[40:43]
    v_mfma_f32_16x16x32_bf16 v[40:43], v[204:207], v[76:79], v[40:43]
    v_mfma_f32_16x16x32_bf16 v[40:43], v[240:243], v[80:83], v[40:43]
    v_mfma_f32_16x16x32_bf16 v[40:43], v[244:247], v[84:87], v[40:43]
    v_mfma_f32_16x16x32_bf16 v[40:43], v[248:251], v[88:91], v[40:43]
    v_mfma_f32_16x16x32_bf16 v[40:43], v[252:255], v[92:95], v[40:43]
    s_nop 7
    ds_write_addtid_b32 v40 offset:6192
    ds_write_addtid_b32 v41 offset:14448
    ds_write_addtid_b32 v42 offset:22704
    ds_write_addtid_b32 v43 offset:30960
    s_waitcnt lgkmcnt(0)
    s_barrier
    s_endpgm
L_fin:
L_end:
    s_endpgm
.section .rodata,"a"
.p2align 6
.amdhsa_kernel standalone__ssm_conv_s4d__prompt_kernel
  .amdhsa_next_free_vgpr 256
  .amdhsa_next_free_sgpr 102
  .amdhsa_accum_offset 256
  .amdhsa_group_segment_fixed_size 0
  .amdhsa_kernarg_size 80
  .amdhsa_user_sgpr_count 2
  .amdhsa_user_sgpr_kernarg_segment_ptr 1
  .amdhsa_system_sgpr_workgroup_id_x 1
.end_amdhsa_kernel
```
